```python
import torch

def _softmax(x, axis=-1):
    return torch.softmax(x, dim=axis)
def _gelu(x):
    return torch.nn.functional.gelu(x, approximate="tanh")
def _silu(x):
    return torch.nn.functional.silu(x)
def _sigmoid(x):
    return torch.sigmoid(x)
def _layernorm(x, axis=-1, eps=1e-5):
    m = x.mean(dim=axis, keepdim=True)
    v = x.var(dim=axis, keepdim=True, unbiased=False)
    return (x - m) / torch.sqrt(v + eps)
def _scatter_add(tgt, idx, src, axis=0):
    return tgt.clone().index_add_(axis, idx, src)
def _segment_sum(src, seg, n):
    out = torch.zeros((n,) + src.shape[1:], dtype=src.dtype)
    return out.index_add_(0, seg, src)
def _pad(x, pw):
    flat = tuple(v for pair in reversed(pw) for v in pair)
    return torch.nn.functional.pad(x, flat)

kernel_name = 'gated_mix__compressed_kv_cla__swiglu_ffn__decode'

def setup_inputs():

    _w = (lambda a: (lambda t: t.to(torch.bfloat16) if t.is_floating_point() else t)(torch.as_tensor(a)))
    def _A_setup():
        B, H, Sq, Sk, D, M = 2, 32, 1, 4096, 128, 640
        Dc = 4 * D
        return {
            "x": _w((lambda *s: torch.randn(*s, dtype=torch.bfloat16) * 0.05)(B, Sq, M)),
            "c_kv": _w((lambda *s: torch.randn(*s, dtype=torch.bfloat16) * 0.8)(B, Sk, Dc)),
            "w_q": _w((lambda *s: torch.randn(*s, dtype=torch.bfloat16) * 6.4)(M, H, D) * (M ** -0.5)),
            "w_uk": _w((lambda *s: torch.randn(*s, dtype=torch.bfloat16) * 6.4)(Dc, H, D) * (Dc ** -0.5)),
            "w_uv": _w((lambda *s: torch.randn(*s, dtype=torch.bfloat16) * 0.8)(Dc, H, D) * (Dc ** -0.5)),
            "w_o": _w((lambda *s: torch.randn(*s, dtype=torch.bfloat16) * 0.8)(H, D, M) * ((H * D) ** -0.5)),
        }
    _A_in = _A_setup()

    def _B_setup():
        B, S, D, F = 2, 1, 640, 1728
        return {
            "x": _w((lambda *s: torch.randn(*s, dtype=torch.bfloat16) * 0.05)(B, S, D)),
            "w_gate": _w((lambda *s: torch.randn(*s, dtype=torch.bfloat16) * 0.1)(D, F)),
            "w_up": _w((lambda *s: torch.randn(*s, dtype=torch.bfloat16) * 0.1)(D, F)),
            "w_down": _w((lambda *s: torch.randn(*s, dtype=torch.bfloat16) * 0.1)(F, D)),
        }
    _B_in = _B_setup()

    return {
        "A_x": _A_in["x"],
        "A_c_kv": _A_in["c_kv"],
        "A_w_q": _A_in["w_q"],
        "A_w_uk": _A_in["w_uk"],
        "A_w_uv": _A_in["w_uv"],
        "A_w_o": _A_in["w_o"],
        "B_x": _B_in["x"],
        "B_w_gate": _B_in["w_gate"],
        "B_w_up": _B_in["w_up"],
        "B_w_down": _B_in["w_down"],
        "gate_w": _w((lambda *s: torch.randn(*s, dtype=torch.bfloat16) * 0.1)(640) * 16.0),
    }

def reference(A_x, A_c_kv, A_w_q, A_w_uk, A_w_uv, A_w_o, B_x, B_w_gate, B_w_up, B_w_down, gate_w):
    def _A_ref(x, c_kv, w_q, w_uk, w_uv, w_o):
        B, Sq, M = x.shape[0], x.shape[1], x.shape[2]
        Sk = c_kv.shape[1]
        H, D = w_q.shape[1], w_q.shape[2]
        q = torch.einsum("bqm,mhd->bhqd", x, w_q)
        k = torch.einsum("bkc,chd->bhkd", c_kv, w_uk)
        v = torch.einsum("bkc,chd->bhkd", c_kv, w_uv)
        scores = torch.einsum("bhqd,bhkd->bhqk", q, k) * (D ** -0.5)
        off = Sk - Sq
        qi = torch.arange(Sq)[:, None]
        kj = torch.arange(Sk)[None, :]
        cmask = kj <= (qi + off)
        scores = torch.where(cmask[None, None], scores, -1e9)
        p = _softmax(scores, axis=-1)
        ctx = torch.einsum("bhqk,bhkd->bhqd", p, v)
        return torch.einsum("bhqd,hdm->bqm", ctx, w_o)

    def _B_ref(x, w_gate, w_up, w_down):
        g = _silu(x @ w_gate)
        u = x @ w_up
        return (g * u) @ w_down

    x = A_x
    g = _sigmoid((x * gate_w).sum(-1, keepdims=True))
    a = _A_ref(x, A_c_kv, A_w_q, A_w_uk, A_w_uv, A_w_o)
    b = _B_ref(x, B_w_gate, B_w_up, B_w_down)
    return g * a + (1 - g) * b
```

```asm
; @launch grid=(256,1,1) block=(256,1,1) lds=155904
.amdgcn_target "amdgcn-amd-amdhsa--gfx950"
.text
.globl gated_mix__compressed_kv_cla__swiglu_ffn__decode_kernel
.p2align 8
.type gated_mix__compressed_kv_cla__swiglu_ffn__decode_kernel,@function
gated_mix__compressed_kv_cla__swiglu_ffn__decode_kernel:
    s_getpc_b64 s[52:53]
    v_subrev_u32 v10, 64, v0
    v_cmp_gt_u32 vcc, 32, v10
    v_lshlrev_b32 v10, 7, v10
    s_and_saveexec_b64 s[54:55], vcc
    s_cbranch_execz L_nopft
    global_load_dword v63, v10, s[52:53]
L_nopft:
    s_mov_b64 exec, -1
    s_load_dwordx2 s[8:9], s[0:1], 0
    s_load_dwordx2 s[32:33], s[0:1], 16
    s_load_dwordx2 s[12:13], s[0:1], 104
    s_cmp_ge_u32 s2, 128
    s_cselect_b32 s40, 8, 24
    s_cselect_b32 s18, 8388608, 0
    s_max_u32 s18, s18, 4194304
    s_load_dwordx2 s[16:17], s[0:1], s40
    s_mov_b32 s19, 0x00020000
    v_lshrrev_b32 v4, 6, v0
    v_and_b32 v1, 63, v0
    v_readfirstlane_b32 s3, v4
    v_and_b32 v2, 15, v0
    v_bfe_u32 v3, v0, 4, 2
    s_and_b32 s4, s2, 7
    s_bfe_u32 s5, s2, 0x40003
    s_and_b32 s6, s5, 3
    s_lshl_b32 s40, s4, 2
    s_add_u32 s6, s6, s40
    s_lshr_b32 s7, s5, 2
    v_lshlrev_b32 v30, 4, v1
    v_lshlrev_b32 v20, 7, v1
    s_lshl_b32 s40, s7, 2
    s_add_u32 s40, s40, s3
    s_lshl_b32 s42, s6, 8
    v_xor_b32 v9, v3, v2
    s_mov_b32 s10, 2560
    s_mov_b32 s11, 0x00020000
    s_mov_b32 s14, 268435456
    s_mov_b32 s15, 0x00020000
    s_mov_b32 s34, 5242880
    s_mov_b32 s35, 0x00020000
    v_lshrrev_b32 v13, 3, v2
    s_lshl_b32 s54, s6, 13
    s_add_u32 s54, s54, 65536
    s_cmp_ge_u32 s2, 256
    s_cbranch_scc1 L_end
    s_lshr_b32 s50, s2, 7
    s_cmp_lg_u32 s3, 0
    s_cbranch_scc1 L_notw0
    s_lshl_b32 s51, s7, 1
    s_add_u32 s51, s51, s50
    s_mul_i32 s43, s51, 655360
    s_add_u32 s43, s43, s42
    s_mul_i32 s41, s51, 160
    s_lshl_b32 s55, s51, 10
    s_add_u32 s55, s55, s54
    v_mul_u32_u24 v4, 1280, v13
    v_lshl_add_u32 v5, v3, 3, v4
    v_lshl_add_u32 v4, v3, 5, v4
    v_lshlrev_b32 v7, 4, v2
    v_lshl_add_u32 v6, v3, 17, v7
    v_lshl_add_u32 v7, v3, 15, v7
    s_waitcnt lgkmcnt(0)
    buffer_load_dword v62, off, s[12:15], 0 offset:0
    buffer_load_dwordx4 v[52:55], v4, s[8:11], s41 offen
    buffer_load_dwordx4 v[56:59], v4, s[8:11], s41 offen offset:16
    buffer_load_dwordx2 v[60:61], v5, s[8:11], s41 offen offset:128
    buffer_load_dwordx4 v[144:147], v6, s[32:35], s43 offen nt
    s_add_u32 s43, s43, 8192
    buffer_load_dwordx4 v[148:151], v6, s[32:35], s43 offen nt
    s_add_u32 s43, s43, 8192
    buffer_load_dwordx4 v[152:155], v6, s[32:35], s43 offen nt
    s_add_u32 s43, s43, 8192
    buffer_load_dwordx4 v[156:159], v6, s[32:35], s43 offen nt
    s_add_u32 s43, s43, 8192
    buffer_load_dwordx4 v[160:163], v6, s[32:35], s43 offen nt
    s_add_u32 s43, s43, 8192
    buffer_load_dwordx4 v[164:167], v6, s[32:35], s43 offen nt
    s_add_u32 s43, s43, 8192
    buffer_load_dwordx4 v[168:171], v6, s[32:35], s43 offen nt
    s_add_u32 s43, s43, 8192
    buffer_load_dwordx4 v[172:175], v6, s[32:35], s43 offen nt
    s_add_u32 s43, s43, 8192
    buffer_load_dwordx4 v[176:179], v6, s[32:35], s43 offen nt
    s_add_u32 s43, s43, 8192
    buffer_load_dwordx4 v[180:183], v6, s[32:35], s43 offen nt
    s_add_u32 s43, s43, 8192
    buffer_load_dwordx4 v[184:187], v6, s[32:35], s43 offen nt
    s_add_u32 s43, s43, 8192
    buffer_load_dwordx4 v[188:191], v6, s[32:35], s43 offen nt
    s_add_u32 s43, s43, 8192
    buffer_load_dwordx4 v[192:195], v6, s[32:35], s43 offen nt
    s_add_u32 s43, s43, 8192
    buffer_load_dwordx4 v[196:199], v6, s[32:35], s43 offen nt
    s_add_u32 s43, s43, 8192
    buffer_load_dwordx4 v[200:203], v6, s[32:35], s43 offen nt
    s_add_u32 s43, s43, 8192
    buffer_load_dwordx4 v[204:207], v6, s[32:35], s43 offen nt
    s_add_u32 s43, s43, 401408
    buffer_load_dwordx4 v[208:211], v7, s[32:35], s43 offen nt
    s_add_u32 s43, s43, 8192
    buffer_load_dwordx4 v[212:215], v7, s[32:35], s43 offen nt
    s_add_u32 s43, s43, 8192
    buffer_load_dwordx4 v[216:219], v7, s[32:35], s43 offen nt
    s_add_u32 s43, s43, 8192
    buffer_load_dwordx4 v[220:223], v7, s[32:35], s43 offen nt
    s_mov_b64 exec, 0xff
    buffer_load_dword v63, v20, s[12:15], s55 offen
    s_mov_b64 exec, -1
    s_barrier
    v_and_b32 v12, 1, v2
    v_lshlrev_b32 v12, 4, v12
    v_mov_b32 v14, 0x0c0c0100
    v_mov_b32 v15, 0x0c0c0302
    v_mov_b32 v16, 0x0c0c0c0c
    v_alignbit_b32 v14, v14, v14, v12
    v_alignbit_b32 v15, v15, v15, v12
    v_bfe_u32 v12, v2, 1, 2
    v_cmp_eq_u32 vcc, 0, v12
    s_nop 1
    v_cndmask_b32 v32, v16, v14, vcc
    v_cndmask_b32 v36, v16, v15, vcc
    v_cmp_eq_u32 vcc, 1, v12
    s_nop 1
    v_cndmask_b32 v33, v16, v14, vcc
    v_cndmask_b32 v37, v16, v15, vcc
    v_cmp_eq_u32 vcc, 2, v12
    s_nop 1
    v_cndmask_b32 v34, v16, v14, vcc
    v_cndmask_b32 v38, v16, v15, vcc
    v_cmp_eq_u32 vcc, 3, v12
    s_nop 1
    v_cndmask_b32 v35, v16, v14, vcc
    v_cndmask_b32 v39, v16, v15, vcc
    s_mov_b32 s56, 0x07060501
    s_mov_b32 s57, 0x07060502
    s_mov_b32 s58, 0x07060503
    s_mov_b32 s59, 0x0c04000c
    s_mov_b32 s60, 0x04020100
    s_waitcnt vmcnt(21)
    v_perm_b32 v64, v52, v52, v32
    v_perm_b32 v65, v52, v52, v33
    v_perm_b32 v66, v52, v52, v34
    v_perm_b32 v67, v52, v52, v35
    v_perm_b32 v68, v52, v52, v36
    v_perm_b32 v69, v52, v52, v37
    v_perm_b32 v70, v52, v52, v38
    v_perm_b32 v71, v52, v52, v39
    v_perm_b32 v72, v53, v53, v32
    v_perm_b32 v73, v53, v53, v33
    v_perm_b32 v74, v53, v53, v34
    v_perm_b32 v75, v53, v53, v35
    v_perm_b32 v76, v53, v53, v36
    v_perm_b32 v77, v53, v53, v37
    v_perm_b32 v78, v53, v53, v38
    v_perm_b32 v79, v53, v53, v39
    v_perm_b32 v80, v54, v54, v32
    v_perm_b32 v81, v54, v54, v33
    v_perm_b32 v82, v54, v54, v34
    v_perm_b32 v83, v54, v54, v35
    v_perm_b32 v84, v54, v54, v36
    v_perm_b32 v85, v54, v54, v37
    v_perm_b32 v86, v54, v54, v38
    v_perm_b32 v87, v54, v54, v39
    v_perm_b32 v88, v55, v55, v32
    v_perm_b32 v89, v55, v55, v33
    v_perm_b32 v90, v55, v55, v34
    v_perm_b32 v91, v55, v55, v35
    v_perm_b32 v92, v55, v55, v36
    v_perm_b32 v93, v55, v55, v37
    v_perm_b32 v94, v55, v55, v38
    v_perm_b32 v95, v55, v55, v39
    v_perm_b32 v96, v56, v56, v32
    v_perm_b32 v97, v56, v56, v33
    v_perm_b32 v98, v56, v56, v34
    v_perm_b32 v99, v56, v56, v35
    v_perm_b32 v100, v56, v56, v36
    v_perm_b32 v101, v56, v56, v37
    v_perm_b32 v102, v56, v56, v38
    v_perm_b32 v103, v56, v56, v39
    v_perm_b32 v104, v57, v57, v32
    v_perm_b32 v105, v57, v57, v33
    v_perm_b32 v106, v57, v57, v34
    v_perm_b32 v107, v57, v57, v35
    v_perm_b32 v108, v57, v57, v36
    v_perm_b32 v109, v57, v57, v37
    v_perm_b32 v110, v57, v57, v38
    v_perm_b32 v111, v57, v57, v39
    v_perm_b32 v112, v58, v58, v32
    v_perm_b32 v113, v58, v58, v33
    v_perm_b32 v114, v58, v58, v34
    v_perm_b32 v115, v58, v58, v35
    v_perm_b32 v116, v58, v58, v36
    v_perm_b32 v117, v58, v58, v37
    v_perm_b32 v118, v58, v58, v38
    v_perm_b32 v119, v58, v58, v39
    v_perm_b32 v120, v59, v59, v32
    v_perm_b32 v121, v59, v59, v33
    v_perm_b32 v122, v59, v59, v34
    v_perm_b32 v123, v59, v59, v35
    v_perm_b32 v124, v59, v59, v36
    v_perm_b32 v125, v59, v59, v37
    v_perm_b32 v126, v59, v59, v38
    v_perm_b32 v127, v59, v59, v39
    v_perm_b32 v128, v60, v60, v32
    v_perm_b32 v129, v60, v60, v33
    v_perm_b32 v130, v60, v60, v34
    v_perm_b32 v131, v60, v60, v35
    v_perm_b32 v132, v60, v60, v36
    v_perm_b32 v133, v60, v60, v37
    v_perm_b32 v134, v60, v60, v38
    v_perm_b32 v135, v60, v60, v39
    v_perm_b32 v136, v61, v61, v32
    v_perm_b32 v137, v61, v61, v33
    v_perm_b32 v138, v61, v61, v34
    v_perm_b32 v139, v61, v61, v35
    v_perm_b32 v140, v61, v61, v36
    v_perm_b32 v141, v61, v61, v37
    v_perm_b32 v142, v61, v61, v38
    v_perm_b32 v143, v61, v61, v39
    s_waitcnt vmcnt(17)
    v_mfma_f32_16x16x32_bf16 v[16:19], v[64:67], v[144:147], 0
    v_mfma_f32_16x16x32_bf16 v[16:19], v[68:71], v[148:151], v[16:19]
    v_mfma_f32_16x16x32_bf16 v[16:19], v[72:75], v[152:155], v[16:19]
    v_mfma_f32_16x16x32_bf16 v[16:19], v[76:79], v[156:159], v[16:19]
    s_waitcnt vmcnt(13)
    v_mfma_f32_16x16x32_bf16 v[16:19], v[80:83], v[160:163], v[16:19]
    v_mfma_f32_16x16x32_bf16 v[16:19], v[84:87], v[164:167], v[16:19]
    v_mfma_f32_16x16x32_bf16 v[16:19], v[88:91], v[168:171], v[16:19]
    v_mfma_f32_16x16x32_bf16 v[16:19], v[92:95], v[172:175], v[16:19]
    s_waitcnt vmcnt(9)
    v_mfma_f32_16x16x32_bf16 v[16:19], v[96:99], v[176:179], v[16:19]
    v_mfma_f32_16x16x32_bf16 v[16:19], v[100:103], v[180:183], v[16:19]
    v_mfma_f32_16x16x32_bf16 v[16:19], v[104:107], v[184:187], v[16:19]
    v_mfma_f32_16x16x32_bf16 v[16:19], v[108:111], v[188:191], v[16:19]
    s_waitcnt vmcnt(5)
    v_mfma_f32_16x16x32_bf16 v[16:19], v[112:115], v[192:195], v[16:19]
    v_mfma_f32_16x16x32_bf16 v[16:19], v[116:119], v[196:199], v[16:19]
    v_mfma_f32_16x16x32_bf16 v[16:19], v[120:123], v[200:203], v[16:19]
    v_mfma_f32_16x16x32_bf16 v[16:19], v[124:127], v[204:207], v[16:19]
    s_waitcnt vmcnt(1)
    v_mfma_f32_16x16x32_bf16 v[16:19], v[128:131], v[208:211], v[16:19]
    v_mfma_f32_16x16x32_bf16 v[16:19], v[132:135], v[212:215], v[16:19]
    v_mfma_f32_16x16x32_bf16 v[16:19], v[136:139], v[216:219], v[16:19]
    v_mfma_f32_16x16x32_bf16 v[16:19], v[140:143], v[220:223], v[16:19]
    v_readfirstlane_b32 s37, v62
    s_nop 6
    v_perm_b32 v48, v16, v19, s56
    v_perm_b32 v49, v17, v19, s57
    v_perm_b32 v50, v18, v19, s58
    s_add_u32 s37, s37, 1
    s_and_b32 s36, s37, 0xbfffbfff
    v_mov_b32 v51, s36
    buffer_store_dwordx4 v[48:51], v30, s[12:15], s55 offen
    s_add_u32 s39, s55, 524288
    buffer_store_dwordx4 v[48:51], v30, s[12:15], s39 offen sc1
    s_branch L_front_done
L_notw0:
    s_cmp_lg_u32 s50, 0
    s_cbranch_scc1 L_A_ld
    v_lshlrev_b32 v8, 13, v3
    v_lshl_add_u32 v8, v9, 4, v8
    s_and_b32 s46, s3, 1
    s_lshl_b32 s44, s7, 20
    s_lshl_b32 s45, s46, 19
    s_add_u32 s44, s44, s45
    s_add_u32 s44, s44, s42
    s_lshl_b32 s45, s46, 14
    s_add_u32 s45, s45, 49152
    s_waitcnt lgkmcnt(0)
    buffer_load_dword v62, off, s[12:15], 0 offset:0
    s_barrier
    s_mov_b32 s61, 0
    s_cmp_eq_u32 s3, 1
    s_cbranch_scc1 L_ld_done
    s_mov_b32 s61, 1
    s_mov_b32 m0, s45
    s_add_u32 s45, s45, 1024
    buffer_load_dwordx4 v8, s[16:19], s44 offen nt lds
    s_add_u32 s44, s44, 32768
    s_mov_b32 m0, s45
    s_add_u32 s45, s45, 1024
    buffer_load_dwordx4 v8, s[16:19], s44 offen nt lds
    s_add_u32 s44, s44, 32768
    v_xor_b32 v8, 64, v8
    s_mov_b32 m0, s45
    s_add_u32 s45, s45, 1024
    buffer_load_dwordx4 v8, s[16:19], s44 offen nt lds
    s_add_u32 s44, s44, 32768
    s_mov_b32 m0, s45
    s_add_u32 s45, s45, 1024
    buffer_load_dwordx4 v8, s[16:19], s44 offen nt lds
    s_add_u32 s44, s44, 32768
    v_xor_b32 v8, 192, v8
    s_mov_b32 m0, s45
    s_add_u32 s45, s45, 1024
    buffer_load_dwordx4 v8, s[16:19], s44 offen nt lds
    s_add_u32 s44, s44, 32768
    s_mov_b32 m0, s45
    s_add_u32 s45, s45, 1024
    buffer_load_dwordx4 v8, s[16:19], s44 offen nt lds
    s_add_u32 s44, s44, 32768
    v_xor_b32 v8, 64, v8
    s_mov_b32 m0, s45
    s_add_u32 s45, s45, 1024
    buffer_load_dwordx4 v8, s[16:19], s44 offen nt lds
    s_add_u32 s44, s44, 32768
    s_mov_b32 m0, s45
    s_add_u32 s45, s45, 1024
    buffer_load_dwordx4 v8, s[16:19], s44 offen nt lds
    s_add_u32 s44, s44, 32768
    v_xor_b32 v8, 192, v8
    s_mov_b32 m0, s45
    s_add_u32 s45, s45, 1024
    buffer_load_dwordx4 v8, s[16:19], s44 offen nt lds
    s_add_u32 s44, s44, 32768
    s_mov_b32 m0, s45
    s_add_u32 s45, s45, 1024
    buffer_load_dwordx4 v8, s[16:19], s44 offen nt lds
    s_add_u32 s44, s44, 32768
    v_xor_b32 v8, 64, v8
    s_mov_b32 m0, s45
    s_add_u32 s45, s45, 1024
    buffer_load_dwordx4 v8, s[16:19], s44 offen nt lds
    s_add_u32 s44, s44, 32768
    s_mov_b32 m0, s45
    s_add_u32 s45, s45, 1024
    buffer_load_dwordx4 v8, s[16:19], s44 offen nt lds
    s_add_u32 s44, s44, 32768
    v_xor_b32 v8, 192, v8
    s_mov_b32 m0, s45
    s_add_u32 s45, s45, 1024
    buffer_load_dwordx4 v8, s[16:19], s44 offen nt lds
    s_add_u32 s44, s44, 32768
    s_mov_b32 m0, s45
    s_add_u32 s45, s45, 1024
    buffer_load_dwordx4 v8, s[16:19], s44 offen nt lds
    s_add_u32 s44, s44, 32768
    v_xor_b32 v8, 64, v8
    s_mov_b32 m0, s45
    s_add_u32 s45, s45, 1024
    buffer_load_dwordx4 v8, s[16:19], s44 offen nt lds
    s_add_u32 s44, s44, 32768
    s_mov_b32 m0, s45
    s_add_u32 s45, s45, 1024
    buffer_load_dwordx4 v8, s[16:19], s44 offen nt lds
    s_add_u32 s44, s44, 32768
    s_branch L_ld_done
L_A_ld:
    s_lshl_b32 s74, s4, 3
    s_and_b32 s45, s5, 7
    s_add_u32 s74, s74, s45
    s_lshl_b32 s74, s74, 17
    s_and_b32 s46, s3, 1
    s_lshl_b32 s46, s46, 6
    s_lshr_b32 s47, s5, 3
    s_lshl_b32 s47, s47, 4
    s_add_u32 s46, s46, s47
    s_mul_i32 s75, s46, 1040
    s_lshl_b32 s46, s46, 10
    s_add_u32 s74, s74, s46
    s_cmp_lg_u32 s3, 1
    s_cbranch_scc1 L_w1
    s_getpc_b64 s[52:53]
L_pc1:
    s_sub_u32 s52, s52, L_pc1-gated_mix__compressed_kv_cla__swiglu_ffn__decode_kernel
    s_subb_u32 s53, s53, 0
    s_mul_i32 s39, s5, 1024
    v_add_u32 v10, s39, v20
    s_mov_b64 exec, 255
    global_load_dword v63, v10, s[52:53]
    s_mov_b64 exec, -1
L_w1:
    s_waitcnt lgkmcnt(0)
    buffer_load_dword v62, off, s[12:15], 0 offset:0
    s_barrier
    s_mov_b32 s61, 0
    s_cmp_eq_u32 s3, 1
    s_cbranch_scc1 L_ld_done
    s_mov_b32 s61, 1
    s_add_u32 s76, s75, 16640
L_dma2:
    s_mov_b32 m0, s75
    s_add_u32 s75, s75, 1040
    buffer_load_dwordx4 v30, s[16:19], s74 offen lds
    s_add_u32 s74, s74, 1024
    s_cmp_lt_u32 s75, s76
    s_cbranch_scc1 L_dma2
L_ld_done:
    v_and_b32 v12, 1, v2
    v_lshlrev_b32 v12, 4, v12
    v_mov_b32 v14, 0x0c0c0100
    v_mov_b32 v15, 0x0c0c0302
    v_mov_b32 v16, 0x0c0c0c0c
    v_alignbit_b32 v14, v14, v14, v12
    v_alignbit_b32 v15, v15, v15, v12
    v_bfe_u32 v12, v2, 1, 2
    v_cmp_eq_u32 vcc, 0, v12
    s_nop 1
    v_cndmask_b32 v32, v16, v14, vcc
    v_cndmask_b32 v36, v16, v15, vcc
    v_cmp_eq_u32 vcc, 1, v12
    s_nop 1
    v_cndmask_b32 v33, v16, v14, vcc
    v_cndmask_b32 v37, v16, v15, vcc
    v_cmp_eq_u32 vcc, 2, v12
    s_nop 1
    v_cndmask_b32 v34, v16, v14, vcc
    v_cndmask_b32 v38, v16, v15, vcc
    v_cmp_eq_u32 vcc, 3, v12
    s_nop 1
    v_cndmask_b32 v35, v16, v14, vcc
    v_cndmask_b32 v39, v16, v15, vcc
    s_mov_b32 s56, 0x07060501
    s_mov_b32 s57, 0x07060502
    s_mov_b32 s58, 0x07060503
    s_mov_b32 s59, 0x0c04000c
    s_mov_b32 s60, 0x04020100
    s_waitcnt vmcnt(16)
    s_cmp_lg_u32 s61, 0
    s_cbranch_scc1 L_eok
    s_waitcnt vmcnt(0)
L_eok:
    v_readfirstlane_b32 s37, v62
    s_add_u32 s37, s37, 1
    s_and_b32 s36, s37, 0xbfffbfff
    v_mov_b32 v51, s36
L_front_done:
    s_mov_b32 s38, 0x5ffff
    s_mov_b32 s61, 63
    s_load_dwordx2 s[28:29], s[0:1], 80
    s_mov_b32 s30, 1280
    s_mov_b32 s31, 0x00020000
    s_cmp_lg_u32 s50, 0
    s_cbranch_scc1 L_A
L_Q:
    s_load_dwordx2 s[16:17], s[0:1], 40
    s_load_dwordx2 s[32:33], s[0:1], 72
    s_load_dwordx4 s[20:23], s[0:1], 56
    s_mov_b32 s18, 5242880
    s_mov_b32 s19, 0x00020000
    s_mov_b32 s34, 2211840
    s_lshl_b32 s52, s3, 10
    s_add_u32 s52, s52, 133120
    v_add_u32 v24, s52, v30
    v_add_u32 v25, 133120, v30
    v_mul_u32_u24 v4, 1280, v13
    v_lshl_add_u32 v5, v3, 2, v4
    v_lshl_add_u32 v4, v3, 4, v4
    s_mul_i32 s41, s40, 80
    buffer_load_dwordx4 v[40:43], v4, s[8:11], s41 offen
    buffer_load_dword v44, v5, s[8:11], s41 offen offset:64
    s_add_u32 s42, s5, 2
    s_and_b32 s42, s42, 3
    s_lshl_b32 s42, s42, 3
    s_add_u32 s42, s42, s4
    v_mul_u32_u24 v240, 10240, v3
    v_lshl_add_u32 v240, v2, 4, v240
    v_mul_u32_u24 v241, 5120, v3
    v_lshl_add_u32 v241, v2, 4, v241
    s_lshl_b32 s44, s6, 2
    s_add_u32 s44, s44, s7
    s_lshl_b32 s39, s3, 8
    s_mul_i32 s45, s44, 40960
    s_add_u32 s45, s45, s39
    s_lshl_b32 s46, s42, 2
    s_add_u32 s46, s46, s7
    s_mul_i32 s46, s46, 20480
    s_add_u32 s46, s46, s39
    v_mov_b32 v16, -1
    v_mov_b32 v17, -1
    v_mov_b32 v18, -1
    v_mov_b32 v19, -1
L_Q_noclr:
    s_cmp_lg_u32 s3, 3
    s_cbranch_scc1 L_w3
    v_lshrrev_b32 v10, 5, v1
    v_lshlrev_b32 v10, 16, v10
    v_and_b32 v11, 31, v1
    v_lshl_add_u32 v10, v11, 4, v10
    s_lshl_b32 s47, s44, 9
    s_add_u32 s47, s47, 1114112
    buffer_store_dwordx4 v[16:19], v10, s[12:15], s47 offen sc1
L_w3:
    v_lshrrev_b32 v10, 2, v2
    v_lshlrev_b32 v10, 11, v10
    v_and_b32 v11, 3, v2
    v_lshl_add_u32 v10, v11, 8, v10
    s_lshl_b32 s47, s3, 13
    s_add_u32 s47, s47, 49152
    v_add_u32 v10, s47, v10
    v_xor_b32 v11, 0, v9
    v_lshl_add_u32 v52, v11, 4, v10
    v_xor_b32 v11, 4, v9
    v_lshl_add_u32 v53, v11, 4, v10
    v_xor_b32 v11, 8, v9
    v_lshl_add_u32 v54, v11, 4, v10
    v_xor_b32 v11, 12, v9
    v_lshl_add_u32 v55, v11, 4, v10
    v_lshrrev_b32 v26, 1, v3
    v_lshlrev_b32 v26, 8, v26
    v_lshl_add_u32 v26, v2, 4, v26
    v_and_b32 v27, 1, v3
    v_lshl_add_u32 v26, v27, 3, v26
    v_add_u32 v26, 40960, v26
    v_and_b32 v27, 1, v2
    v_lshlrev_b32 v28, 8, v27
    v_lshl_add_u32 v28, v3, 4, v28
    v_add_u32 v28, 40960, v28
    v_lshlrev_b32 v29, 16, v27
    v_bfe_u32 v31, v2, 1, 1
    v_lshl_add_u32 v29, v31, 6, v29
    v_lshl_add_u32 v29, v3, 4, v29
    v_cmp_ne_u32 s[52:53], 0, v31
    s_lshl_b32 s47, s6, 4
    s_add_u32 s47, s47, s40
    s_lshl_b32 s47, s47, 7
    s_add_u32 s47, s47, 1114112
    s_mov_b32 s50, 0x3e0293ee
    v_mov_b32 v50, s36
    s_lshl_b32 s55, s44, 7
    s_add_u32 s55, s55, 1245184
    s_waitcnt lgkmcnt(0)
    v_cmp_gt_u32 vcc, 8, v2
    v_mov_b32 v8, s22
    v_mov_b32 v9, s23
    v_mov_b32 v10, s20
    v_mov_b32 v11, s21
    v_cndmask_b32 v8, v8, v10, vcc
    v_cndmask_b32 v9, v9, v11, vcc
    v_and_b32 v14, 7, v2
    v_lshlrev_b32 v14, 4, v14
    s_mul_i32 s48, s40, 138240
    s_lshl_b32 s49, s42, 7
    s_add_u32 s48, s48, s49
    s_add_u32 s48, s48, 3456
    v_add_u32 v14, s48, v14
    v_mul_u32_u24 v252, 27648, v3
    v_add_u32 v252, v252, v14
    v_mov_b32 v253, 0
    v_mul_u32_u24 v254, 6912, v3
    v_add_u32 v254, v254, v14
    v_add_u32 v254, 110592, v254
    v_mov_b32 v255, 0
    v_lshl_add_u64 v[252:253], v[8:9], 0, v[252:253]
    v_lshl_add_u64 v[254:255], v[8:9], 0, v[254:255]
    s_mov_b32 s48, 6912
    s_mov_b32 s49, 0
    v_bfe_u32 v45, v2, 1, 2
    v_lshlrev_b32 v45, 10, v45
    v_lshl_add_u32 v45, v13, 7, v45
    v_lshl_add_u32 v45, v27, 6, v45
    v_lshl_add_u32 v45, v3, 4, v45
    v_add_u32 v12, 4096, v30
    s_cmp_lg_u32 s3, 2
    s_cbranch_scc1 L_w4
    s_waitcnt vmcnt(2)
L_w4:
    s_cmp_lg_u32 s3, 3
    s_cbranch_scc1 L_w5
    s_waitcnt vmcnt(3)
L_w5:
    s_barrier
    s_cmp_eq_u32 s3, 1
    s_cbranch_scc1 L_Q_w1a
    ds_read_b128 v[208:211], v52 offset:0
    ds_read_b128 v[212:215], v53 offset:0
    ds_read_b128 v[216:219], v54 offset:0
    ds_read_b128 v[220:223], v55 offset:0
    ds_read_b128 v[224:227], v52 offset:1024
    ds_read_b128 v[228:231], v53 offset:1024
    ds_read_b128 v[232:235], v54 offset:1024
    ds_read_b128 v[236:239], v55 offset:1024
    s_waitcnt vmcnt(0)
    v_perm_b32 v64, v40, v40, v32
    v_perm_b32 v65, v40, v40, v33
    v_perm_b32 v66, v40, v40, v34
    v_perm_b32 v67, v40, v40, v35
    v_perm_b32 v68, v40, v40, v36
    v_perm_b32 v69, v40, v40, v37
    v_perm_b32 v70, v40, v40, v38
    v_perm_b32 v71, v40, v40, v39
    v_perm_b32 v72, v41, v41, v32
    v_perm_b32 v73, v41, v41, v33
    v_perm_b32 v74, v41, v41, v34
    v_perm_b32 v75, v41, v41, v35
    v_perm_b32 v76, v41, v41, v36
    v_perm_b32 v77, v41, v41, v37
    v_perm_b32 v78, v41, v41, v38
    v_perm_b32 v79, v41, v41, v39
    v_perm_b32 v80, v42, v42, v32
    v_perm_b32 v81, v42, v42, v33
    v_perm_b32 v82, v42, v42, v34
    v_perm_b32 v83, v42, v42, v35
    v_perm_b32 v84, v42, v42, v36
    v_perm_b32 v85, v42, v42, v37
    v_perm_b32 v86, v42, v42, v38
    v_perm_b32 v87, v42, v42, v39
    v_perm_b32 v88, v43, v43, v32
    v_perm_b32 v89, v43, v43, v33
    v_perm_b32 v90, v43, v43, v34
    v_perm_b32 v91, v43, v43, v35
    v_perm_b32 v92, v43, v43, v36
    v_perm_b32 v93, v43, v43, v37
    v_perm_b32 v94, v43, v43, v38
    v_perm_b32 v95, v43, v43, v39
    v_perm_b32 v96, v44, v44, v32
    v_perm_b32 v97, v44, v44, v33
    v_perm_b32 v98, v44, v44, v34
    v_perm_b32 v99, v44, v44, v35
    v_perm_b32 v100, v44, v44, v36
    v_perm_b32 v101, v44, v44, v37
    v_perm_b32 v102, v44, v44, v38
    v_perm_b32 v103, v44, v44, v39
    s_branch L_Q_qbar
L_Q_w1a:
    buffer_load_dwordx4 v[144:147], v30, s[12:15], s54 offen offset:0 sc1
    buffer_load_dwordx4 v[148:151], v30, s[12:15], s54 offen offset:1024 sc1
    buffer_load_dwordx4 v[152:155], v30, s[12:15], s54 offen offset:2048 sc1
    buffer_load_dwordx4 v[156:159], v30, s[12:15], s54 offen offset:3072 sc1
    buffer_load_dwordx4 v[160:163], v12, s[12:15], s54 offen offset:0 sc1
    buffer_load_dwordx4 v[164:167], v12, s[12:15], s54 offen offset:1024 sc1
    buffer_load_dwordx4 v[168:171], v12, s[12:15], s54 offen offset:2048 sc1
    buffer_load_dwordx4 v[172:175], v12, s[12:15], s54 offen offset:3072 sc1
    s_or_b32 s38, s38, s61
    ds_read_b128 v[208:211], v52 offset:0
    ds_read_b128 v[212:215], v53 offset:0
    ds_read_b128 v[216:219], v54 offset:0
    ds_read_b128 v[220:223], v55 offset:0
    ds_read_b128 v[224:227], v52 offset:1024
    ds_read_b128 v[228:231], v53 offset:1024
    ds_read_b128 v[232:235], v54 offset:1024
    ds_read_b128 v[236:239], v55 offset:1024
    s_branch L_poll6c
L_poll6:
    s_and_b32 s39, s38, s61
    s_cselect_b32 s61, s61, 1
    s_cselect_b32 s39, 0, 524288
    s_add_u32 s39, s39, s54
    s_mov_b64 exec, s[62:63]
    buffer_load_dwordx4 v[144:147], v30, s[12:15], s39 offen offset:0 sc1
    s_mov_b64 exec, s[64:65]
    buffer_load_dwordx4 v[148:151], v30, s[12:15], s39 offen offset:1024 sc1
    s_mov_b64 exec, s[66:67]
    buffer_load_dwordx4 v[152:155], v30, s[12:15], s39 offen offset:2048 sc1
    s_mov_b64 exec, s[68:69]
    buffer_load_dwordx4 v[156:159], v30, s[12:15], s39 offen offset:3072 sc1
    s_mov_b64 exec, s[70:71]
    buffer_load_dwordx4 v[160:163], v12, s[12:15], s39 offen offset:0 sc1
    s_mov_b64 exec, s[72:73]
    buffer_load_dwordx4 v[164:167], v12, s[12:15], s39 offen offset:1024 sc1
    s_mov_b64 exec, s[74:75]
    buffer_load_dwordx4 v[168:171], v12, s[12:15], s39 offen offset:2048 sc1
    s_mov_b64 exec, s[76:77]
    buffer_load_dwordx4 v[172:175], v12, s[12:15], s39 offen offset:3072 sc1
    s_mov_b64 exec, -1
    s_sub_u32 s38, s38, 1
    s_cbranch_scc1 L_end
L_poll6c:
    s_waitcnt vmcnt(0)
L_poll6d:
    v_cmp_ne_u32 s[62:63], s36, v147
    v_cmp_ne_u32 s[64:65], s36, v151
    v_cmp_ne_u32 s[66:67], s36, v155
    v_cmp_ne_u32 s[68:69], s36, v159
    v_cmp_ne_u32 s[70:71], s36, v163
    v_cmp_ne_u32 s[72:73], s36, v167
    v_cmp_ne_u32 s[74:75], s36, v171
    v_cmp_ne_u32 s[76:77], s36, v175
    s_or_b64 vcc, s[62:63], s[64:65]
    s_or_b64 vcc, vcc, s[66:67]
    s_or_b64 vcc, vcc, s[68:69]
    s_or_b64 vcc, vcc, s[70:71]
    s_or_b64 vcc, vcc, s[72:73]
    s_or_b64 vcc, vcc, s[74:75]
    s_or_b64 vcc, vcc, s[76:77]
    s_cbranch_scc1 L_poll6
    v_perm_b32 v147, v145, v144, s59
    v_perm_b32 v147, v146, v147, s60
    v_perm_b32 v151, v149, v148, s59
    v_perm_b32 v151, v150, v151, s60
    v_perm_b32 v155, v153, v152, s59
    v_perm_b32 v155, v154, v155, s60
    v_perm_b32 v159, v157, v156, s59
    v_perm_b32 v159, v158, v159, s60
    v_perm_b32 v163, v161, v160, s59
    v_perm_b32 v163, v162, v163, s60
    v_perm_b32 v167, v165, v164, s59
    v_perm_b32 v167, v166, v167, s60
    v_perm_b32 v171, v169, v168, s59
    v_perm_b32 v171, v170, v171, s60
    v_perm_b32 v175, v173, v172, s59
    v_perm_b32 v175, v174, v175, s60
    v_pk_add_f32 v[144:145], v[144:145], v[148:149]
    v_pk_add_f32 v[146:147], v[146:147], v[150:151]
    v_pk_add_f32 v[152:153], v[152:153], v[156:157]
    v_pk_add_f32 v[154:155], v[154:155], v[158:159]
    v_pk_add_f32 v[144:145], v[144:145], v[152:153]
    v_pk_add_f32 v[146:147], v[146:147], v[154:155]
    v_pk_add_f32 v[160:161], v[160:161], v[164:165]
    v_pk_add_f32 v[162:163], v[162:163], v[166:167]
    v_pk_add_f32 v[168:169], v[168:169], v[172:173]
    v_pk_add_f32 v[170:171], v[170:171], v[174:175]
    v_pk_add_f32 v[160:161], v[160:161], v[168:169]
    v_pk_add_f32 v[162:163], v[162:163], v[170:171]
    v_pk_add_f32 v[144:145], v[144:145], v[160:161]
    v_pk_add_f32 v[146:147], v[146:147], v[162:163]
    v_cvt_pk_bf16_f32 v8, v144, v145
    v_cvt_pk_bf16_f32 v9, v146, v147
    ds_write_b64 v26, v[8:9]
L_Q_qbar:
    s_waitcnt lgkmcnt(0)
    s_barrier
    ds_read_b128 v[8:11], v28 offset:0
    ds_read_b128 v[12:15], v28 offset:64
    ds_read_b128 v[16:19], v28 offset:128
    ds_read_b128 v[20:23], v28 offset:192
    s_waitcnt lgkmcnt(3)
    v_mfma_f32_16x16x32_bf16 v[56:59], v[208:211], v[8:11], 0
    v_mfma_f32_16x16x32_bf16 v[60:63], v[224:227], v[8:11], 0
    s_waitcnt lgkmcnt(2)
    v_mfma_f32_16x16x32_bf16 v[56:59], v[212:215], v[12:15], v[56:59]
    v_mfma_f32_16x16x32_bf16 v[60:63], v[228:231], v[12:15], v[60:63]
    s_waitcnt lgkmcnt(1)
    v_mfma_f32_16x16x32_bf16 v[56:59], v[216:219], v[16:19], v[56:59]
    v_mfma_f32_16x16x32_bf16 v[60:63], v[232:235], v[16:19], v[60:63]
    s_waitcnt lgkmcnt(0)
    v_mfma_f32_16x16x32_bf16 v[56:59], v[220:223], v[20:23], v[56:59]
    v_mfma_f32_16x16x32_bf16 v[60:63], v[236:239], v[20:23], v[60:63]
    s_nop 7
    v_cndmask_b32 v56, v56, v60, s[52:53]
    v_cndmask_b32 v57, v57, v61, s[52:53]
    v_cndmask_b32 v58, v58, v62, s[52:53]
    v_cndmask_b32 v59, v59, v63, s[52:53]
    v_mul_f32 v56, s50, v56
    v_mul_f32 v57, s50, v57
    v_mul_f32 v58, s50, v58
    v_mul_f32 v59, s50, v59
    v_cvt_pk_bf16_f32 v48, v56, v57
    v_cvt_pk_bf16_f32 v49, v58, v59
    s_mov_b32 exec_lo, 0x000f000f
    s_mov_b32 exec_hi, 0x000f000f
    buffer_store_dwordx4 v[48:51], v29, s[12:15], s47 offen sc1
    s_mov_b64 exec, -1
    s_cmp_lg_u32 s3, 3
    s_cbranch_scc1 L_w7
    v_lshlrev_b32 v4, 2, v1
    buffer_load_dwordx4 v[144:147], v30, s[8:11], 0 offen
    buffer_load_dword v148, v4, s[8:11], 0 offen offset:1024
    buffer_load_dwordx4 v[152:155], v30, s[8:11], 0 offen offset:1280
    buffer_load_dword v156, v4, s[8:11], 0 offen offset:2304
    buffer_load_dwordx4 v[160:163], v30, s[28:31], 0 offen
    buffer_load_dword v164, v4, s[28:31], 0 offen offset:1024
    s_lshl_b32 s47, s44, 10
    s_add_u32 s47, s47, 458752
    v_lshlrev_b32 v20, 7, v1
    s_mov_b64 exec, 0xff
    buffer_load_dword v63, v20, s[12:15], s47 offen
    s_sub_u32 s47, s47, 131072
    buffer_load_dword v63, v20, s[12:15], s47 offen
    s_mov_b64 exec, -1
L_w7:
    s_cmp_ge_u32 s42, 27
    s_cbranch_scc1 L_Q_nof1
    global_load_dwordx4 v[104:107], v[252:253], off offset:-3456 nt
    global_load_dwordx4 v[108:111], v[252:253], off offset:0 nt
    v_lshl_add_u64 v[252:253], v[252:253], 0, s[48:49]
    global_load_dwordx4 v[112:115], v[252:253], off offset:-3456 nt
    global_load_dwordx4 v[116:119], v[252:253], off offset:0 nt
    v_lshl_add_u64 v[252:253], v[252:253], 0, s[48:49]
    global_load_dwordx4 v[120:123], v[252:253], off offset:-3456 nt
    global_load_dwordx4 v[124:127], v[252:253], off offset:0 nt
    v_lshl_add_u64 v[252:253], v[252:253], 0, s[48:49]
    global_load_dwordx4 v[128:131], v[252:253], off offset:-3456 nt
    global_load_dwordx4 v[132:135], v[252:253], off offset:0 nt
    global_load_dwordx4 v[136:139], v[254:255], off offset:-3456 nt
    global_load_dwordx4 v[140:143], v[254:255], off offset:0 nt
L_Q_nof1:
    s_cmp_lg_u32 s3, 1
    s_cbranch_scc1 L_w8
    v_perm_b32 v64, v40, v40, v32
    v_perm_b32 v65, v40, v40, v33
    v_perm_b32 v66, v40, v40, v34
    v_perm_b32 v67, v40, v40, v35
    v_perm_b32 v68, v40, v40, v36
    v_perm_b32 v69, v40, v40, v37
    v_perm_b32 v70, v40, v40, v38
    v_perm_b32 v71, v40, v40, v39
    v_perm_b32 v72, v41, v41, v32
    v_perm_b32 v73, v41, v41, v33
    v_perm_b32 v74, v41, v41, v34
    v_perm_b32 v75, v41, v41, v35
    v_perm_b32 v76, v41, v41, v36
    v_perm_b32 v77, v41, v41, v37
    v_perm_b32 v78, v41, v41, v38
    v_perm_b32 v79, v41, v41, v39
    v_perm_b32 v80, v42, v42, v32
    v_perm_b32 v81, v42, v42, v33
    v_perm_b32 v82, v42, v42, v34
    v_perm_b32 v83, v42, v42, v35
    v_perm_b32 v84, v42, v42, v36
    v_perm_b32 v85, v42, v42, v37
    v_perm_b32 v86, v42, v42, v38
    v_perm_b32 v87, v42, v42, v39
    v_perm_b32 v88, v43, v43, v32
    v_perm_b32 v89, v43, v43, v33
    v_perm_b32 v90, v43, v43, v34
    v_perm_b32 v91, v43, v43, v35
    v_perm_b32 v92, v43, v43, v36
    v_perm_b32 v93, v43, v43, v37
    v_perm_b32 v94, v43, v43, v38
    v_perm_b32 v95, v43, v43, v39
    v_perm_b32 v96, v44, v44, v32
    v_perm_b32 v97, v44, v44, v33
    v_perm_b32 v98, v44, v44, v34
    v_perm_b32 v99, v44, v44, v35
    v_perm_b32 v100, v44, v44, v36
    v_perm_b32 v101, v44, v44, v37
    v_perm_b32 v102, v44, v44, v38
    v_perm_b32 v103, v44, v44, v39
L_w8:
    s_add_u32 s39, s46, 0
    buffer_load_dwordx4 a[0:3], v241, s[32:35], s39 offen offset:0 nt
    buffer_load_dwordx4 a[4:7], v241, s[32:35], s39 offen offset:1280 nt
    s_add_u32 s39, s46, 2560
    buffer_load_dwordx4 a[8:11], v241, s[32:35], s39 offen offset:0 nt
    buffer_load_dwordx4 a[12:15], v241, s[32:35], s39 offen offset:1280 nt
    s_add_u32 s39, s45, 0
    buffer_load_dwordx4 a[16:19], v240, s[16:19], s39 offen offset:0 nt
    buffer_load_dwordx4 a[20:23], v240, s[16:19], s39 offen offset:1280 nt
    s_add_u32 s39, s45, 2560
    buffer_load_dwordx4 a[24:27], v240, s[16:19], s39 offen offset:0 nt
    buffer_load_dwordx4 a[28:31], v240, s[16:19], s39 offen offset:1280 nt
    s_add_u32 s39, s45, 5120
    buffer_load_dwordx4 a[32:35], v240, s[16:19], s39 offen offset:0 nt
    buffer_load_dwordx4 a[36:39], v240, s[16:19], s39 offen offset:1280 nt
    s_add_u32 s39, s45, 7680
    buffer_load_dwordx4 a[40:43], v240, s[16:19], s39 offen offset:0 nt
    buffer_load_dwordx4 a[44:47], v240, s[16:19], s39 offen offset:1280 nt
    s_lshl_b32 s41, s6, 12
    s_lshl_b32 s47, s7, 8
    s_add_u32 s41, s41, s47
    s_add_u32 s41, s41, 327680
    s_cmp_ge_u32 s42, 27
    s_cbranch_scc1 L_Q_f1skip
    s_waitcnt vmcnt(20)
    v_mfma_f32_16x16x32_bf16 v[16:19], v[64:67], v[104:107], 0
    v_mfma_f32_16x16x32_bf16 v[16:19], v[68:71], v[108:111], v[16:19]
    s_waitcnt vmcnt(18)
    v_mfma_f32_16x16x32_bf16 v[16:19], v[72:75], v[112:115], v[16:19]
    v_mfma_f32_16x16x32_bf16 v[16:19], v[76:79], v[116:119], v[16:19]
    s_waitcnt vmcnt(16)
    v_mfma_f32_16x16x32_bf16 v[16:19], v[80:83], v[120:123], v[16:19]
    v_mfma_f32_16x16x32_bf16 v[16:19], v[84:87], v[124:127], v[16:19]
    s_waitcnt vmcnt(14)
    v_mfma_f32_16x16x32_bf16 v[16:19], v[88:91], v[128:131], v[16:19]
    v_mfma_f32_16x16x32_bf16 v[16:19], v[92:95], v[132:135], v[16:19]
    s_waitcnt vmcnt(12)
    v_mfma_f32_16x16x32_bf16 v[16:19], v[96:99], v[136:139], v[16:19]
    v_mfma_f32_16x16x32_bf16 v[16:19], v[100:103], v[140:143], v[16:19]
    s_nop 7
    ds_write_b128 v24, v[16:19]
L_Q_f1skip:
    s_waitcnt lgkmcnt(0)
    s_barrier
    s_cmp_lg_u32 s3, 0
    s_cbranch_scc1 L_w9
    s_cmp_ge_u32 s42, 27
    s_cbranch_scc1 L_np10
    ds_read_b128 v[144:147], v25 offset:0
    ds_read_b128 v[148:151], v25 offset:1024
    ds_read_b128 v[152:155], v25 offset:2048
    ds_read_b128 v[156:159], v25 offset:3072
    s_waitcnt lgkmcnt(0)
    v_pk_add_f32 v[144:145], v[144:145], v[148:149]
    v_pk_add_f32 v[146:147], v[146:147], v[150:151]
    v_pk_add_f32 v[152:153], v[152:153], v[156:157]
    v_pk_add_f32 v[154:155], v[154:155], v[158:159]
    v_pk_add_f32 v[144:145], v[144:145], v[152:153]
    v_pk_add_f32 v[146:147], v[146:147], v[154:155]
    v_perm_b32 v48, v144, v147, s56
    v_perm_b32 v49, v145, v147, s57
    v_perm_b32 v50, v146, v147, s58
    buffer_store_dwordx4 v[48:51], v45, s[12:15], s41 offen
    s_add_u32 s39, s41, 524288
    buffer_store_dwordx4 v[48:51], v45, s[12:15], s39 offen sc1
L_np10:
L_w9:
    s_cmp_lg_u32 s3, 3
    s_cbranch_scc1 L_w11
    s_waitcnt vmcnt(12)
    v_mov_b32 v8, 0
    v_mov_b32 v9, 0
    v_dot2_f32_bf16 v8, v144, v160, v8
    v_dot2_f32_bf16 v9, v152, v160, v9
    v_dot2_f32_bf16 v8, v145, v161, v8
    v_dot2_f32_bf16 v9, v153, v161, v9
    v_dot2_f32_bf16 v8, v146, v162, v8
    v_dot2_f32_bf16 v9, v154, v162, v9
    v_dot2_f32_bf16 v8, v147, v163, v8
    v_dot2_f32_bf16 v9, v155, v163, v9
    v_dot2_f32_bf16 v8, v148, v164, v8
    v_dot2_f32_bf16 v9, v156, v164, v9
    s_nop 2
    v_add_f32_dpp v8, v8, v8 row_ror:1 row_mask:0xf bank_mask:0xf
    v_add_f32_dpp v9, v9, v9 row_ror:1 row_mask:0xf bank_mask:0xf
    s_nop 0
    v_add_f32_dpp v8, v8, v8 row_ror:2 row_mask:0xf bank_mask:0xf
    v_add_f32_dpp v9, v9, v9 row_ror:2 row_mask:0xf bank_mask:0xf
    s_nop 0
    v_add_f32_dpp v8, v8, v8 row_ror:4 row_mask:0xf bank_mask:0xf
    v_add_f32_dpp v9, v9, v9 row_ror:4 row_mask:0xf bank_mask:0xf
    s_nop 0
    v_add_f32_dpp v8, v8, v8 row_ror:8 row_mask:0xf bank_mask:0xf
    v_add_f32_dpp v9, v9, v9 row_ror:8 row_mask:0xf bank_mask:0xf
    v_mov_b32 v10, v8
    v_mov_b32 v11, v9
    s_nop 0
    v_permlane16_swap_b32 v8, v10
    v_permlane16_swap_b32 v9, v11
    v_add_f32 v8, v8, v10
    v_add_f32 v9, v9, v11
    v_mov_b32 v10, v8
    v_mov_b32 v11, v9
    s_nop 0
    v_permlane32_swap_b32 v8, v10
    v_permlane32_swap_b32 v9, v11
    v_add_f32 v8, v8, v10
    v_add_f32 v9, v9, v11
    s_mov_b32 s39, 0xbfb8aa3b
    v_mul_f32 v8, s39, v8
    v_mul_f32 v9, s39, v9
    v_exp_f32 v8, v8
    v_exp_f32 v9, v9
    v_add_f32 v8, 1.0, v8
    v_add_f32 v9, 1.0, v9
    v_rcp_f32 v8, v8
    v_rcp_f32 v9, v9
    v_sub_f32 v10, 1.0, v8
    v_sub_f32 v11, 1.0, v9
    v_mov_b32 v12, 154112
    ds_write_b128 v12, v[8:11]
L_w11:
    s_cmp_lg_u32 s3, 1
    s_cbranch_scc1 L_w12
    s_add_u32 s39, s46, 0
    buffer_load_dwordx4 a[48:51], v241, s[32:35], s39 offen offset:768 nt
    buffer_load_dwordx4 a[52:55], v241, s[32:35], s39 offen offset:2048 nt
    s_add_u32 s39, s46, 2560
    buffer_load_dwordx4 a[56:59], v241, s[32:35], s39 offen offset:768 nt
    buffer_load_dwordx4 a[60:63], v241, s[32:35], s39 offen offset:2048 nt
    s_add_u32 s39, s45, 0
    buffer_load_dwordx4 a[64:67], v240, s[16:19], s39 offen offset:768 nt
    buffer_load_dwordx4 a[68:71], v240, s[16:19], s39 offen offset:2048 nt
    s_add_u32 s39, s45, 2560
    buffer_load_dwordx4 a[72:75], v240, s[16:19], s39 offen offset:768 nt
    buffer_load_dwordx4 a[76:79], v240, s[16:19], s39 offen offset:2048 nt
    s_add_u32 s39, s45, 5120
    buffer_load_dwordx4 a[80:83], v240, s[16:19], s39 offen offset:768 nt
    buffer_load_dwordx4 a[84:87], v240, s[16:19], s39 offen offset:2048 nt
    s_add_u32 s39, s45, 7680
    buffer_load_dwordx4 a[88:91], v240, s[16:19], s39 offen offset:768 nt
    buffer_load_dwordx4 a[92:95], v240, s[16:19], s39 offen offset:2048 nt
L_w12:
    s_waitcnt lgkmcnt(0)
    s_barrier
    s_lshl_b32 s39, s44, 10
    s_add_u32 s39, s39, 327680
    buffer_load_dwordx4 v[104:107], v30, s[12:15], s39 offen sc1
    v_mov_b32 v14, 154112
    ds_read_b128 v[16:19], v14
    s_lshl_b32 s47, s3, 8
    s_add_u32 s47, s47, 154176
    v_bfe_u32 v4, v1, 1, 1
    v_bfe_u32 v5, v1, 2, 1
    v_and_b32 v6, 1, v1
    v_lshlrev_b32 v242, 5, v4
    v_lshl_add_u32 v242, v5, 4, v242
    v_lshl_add_u32 v242, v6, 3, v242
    v_add_u32 v242, s47, v242
    v_lshrrev_b32 v7, 3, v2
    v_lshlrev_b32 v243, 5, v7
    v_lshl_add_u32 v243, v3, 3, v243
    v_add_u32 v243, s47, v243
    v_bfe_u32 v6, v1, 3, 1
    v_and_b32 v15, 3, v1
    v_lshlrev_b32 v244, 6, v5
    v_lshl_add_u32 v244, v6, 5, v244
    v_lshl_add_u32 v244, v15, 3, v244
    v_add_u32 v244, s47, v244
    v_lshlrev_b32 v245, 6, v7
    v_lshl_add_u32 v245, v3, 4, v245
    v_add_u32 v245, s47, v245
    s_lshl_b32 s47, s44, 10
    s_add_u32 s48, s47, 327680
    s_add_u32 s49, s47, 458752
    v_lshrrev_b32 v246, 3, v1
    v_lshlrev_b32 v246, 14, v246
    v_and_b32 v15, 7, v1
    v_lshl_add_u32 v246, v15, 4, v246
    s_lshl_b32 s50, s44, 7
    s_lshl_b32 s47, s3, 17
    s_add_u32 s50, s50, s47
    s_add_u32 s50, s50, 1310720
    v_cmp_ne_u32 vcc, 0, v4
    s_waitcnt lgkmcnt(0)
    s_nop 0
    v_cndmask_b32 v247, v18, v19, vcc
    v_cmp_ne_u32 vcc, 0, v5
    s_nop 1
    v_cndmask_b32 v248, v16, v17, vcc
    v_mov_b32 v96, 0
    v_mov_b32 v108, 0
    v_mov_b32 v97, 0
    v_mov_b32 v109, 0
    v_mov_b32 v98, 0
    v_mov_b32 v110, 0
    v_mov_b32 v99, 0
    v_mov_b32 v111, 0
    v_mov_b32 v103, s36
    v_mov_b32 v115, s36
    v_mov_b32 v16, -1
    v_mov_b32 v17, -1
    v_mov_b32 v18, -1
    v_mov_b32 v19, -1
    buffer_store_dwordx4 v[16:19], v246, s[12:15], s50 offen sc1
    s_cmp_lg_u32 s3, 1
    s_cbranch_scc1 L_w13
    s_add_u32 s47, s50, 393216
    buffer_store_dwordx4 v[16:19], v246, s[12:15], s47 offen sc1
L_w13:
    s_cmp_ge_u32 s42, 27
    s_cbranch_scc1 L_noffn14
    s_or_b32 s38, s38, s61
    s_branch L_poll15c
L_poll15:
    s_and_b32 s39, s38, s61
    s_cselect_b32 s61, s61, 1
    s_cselect_b32 s39, 0, 524288
    s_add_u32 s39, s39, s48
    s_mov_b64 exec, s[62:63]
    buffer_load_dwordx4 v[104:107], v30, s[12:15], s39 offen offset:0 sc1
    s_mov_b64 exec, -1
    s_sub_u32 s38, s38, 1
    s_cbranch_scc1 L_end
L_poll15c:
    s_waitcnt vmcnt(0)
L_poll15d:
    v_cmp_ne_u32 s[62:63], s36, v107
    s_cmp_lg_u64 s[62:63], 0
    s_cbranch_scc1 L_poll15
    v_perm_b32 v107, v105, v104, s59
    v_perm_b32 v107, v106, v107, s60
    v_mov_b32 v8, v104
    v_mov_b32 v9, v105
    v_mov_b32 v10, v106
    v_mov_b32 v11, v107
    v_mov_b32 v12, v8
    v_mov_b32 v13, v9
    v_mov_b32 v14, v10
    v_mov_b32 v15, v11
    v_permlane16_swap_b32 v8, v12
    v_permlane16_swap_b32 v9, v13
    v_permlane16_swap_b32 v10, v14
    v_permlane16_swap_b32 v11, v15
    v_add_f32 v8, v8, v12
    v_add_f32 v9, v9, v13
    v_add_f32 v10, v10, v14
    v_add_f32 v11, v11, v15
    v_mov_b32 v12, v8
    v_mov_b32 v13, v9
    v_mov_b32 v14, v10
    v_mov_b32 v15, v11
    v_permlane32_swap_b32 v8, v12
    v_permlane32_swap_b32 v9, v13
    v_permlane32_swap_b32 v10, v14
    v_permlane32_swap_b32 v11, v15
    v_add_f32 v8, v8, v12
    v_add_f32 v9, v9, v13
    v_add_f32 v10, v10, v14
    v_add_f32 v11, v11, v15
    v_mov_b32_dpp v12, v8 row_ror:8 row_mask:0xf bank_mask:0xf
    v_mov_b32_dpp v13, v9 row_ror:8 row_mask:0xf bank_mask:0xf
    v_mov_b32_dpp v14, v10 row_ror:8 row_mask:0xf bank_mask:0xf
    v_mov_b32_dpp v15, v11 row_ror:8 row_mask:0xf bank_mask:0xf
    s_mov_b32 s39, 0xbfb8aa3b
    v_mul_f32 v16, s39, v8
    v_mul_f32 v17, s39, v9
    v_mul_f32 v18, s39, v10
    v_mul_f32 v19, s39, v11
    v_exp_f32 v16, v16
    v_exp_f32 v17, v17
    v_exp_f32 v18, v18
    v_exp_f32 v19, v19
    v_add_f32 v16, 1.0, v16
    v_add_f32 v17, 1.0, v17
    v_add_f32 v18, 1.0, v18
    v_add_f32 v19, 1.0, v19
    v_rcp_f32 v16, v16
    v_rcp_f32 v17, v17
    v_rcp_f32 v18, v18
    v_rcp_f32 v19, v19
    v_mul_f32 v8, v8, v12
    v_mul_f32 v9, v9, v13
    v_mul_f32 v10, v10, v14
    v_mul_f32 v11, v11, v15
    v_mul_f32 v16, v16, v247
    v_mul_f32 v17, v17, v247
    v_mul_f32 v18, v18, v247
    v_mul_f32 v19, v19, v247
    v_mul_f32 v8, v8, v16
    v_mul_f32 v9, v9, v17
    v_mul_f32 v10, v10, v18
    v_mul_f32 v11, v11, v19
    v_cvt_pk_bf16_f32 v8, v8, v9
    v_cvt_pk_bf16_f32 v9, v10, v11
    s_mov_b64 exec, 0xff
    ds_write_b64 v242, v[8:9]
    s_mov_b64 exec, -1
    s_waitcnt lgkmcnt(0)
    ds_read_b64 v[8:9], v243
    s_waitcnt lgkmcnt(0)
    v_perm_b32 v64, v8, v8, v32
    v_perm_b32 v65, v8, v8, v33
    v_perm_b32 v66, v8, v8, v34
    v_perm_b32 v67, v8, v8, v35
    v_perm_b32 v68, v8, v8, v36
    v_perm_b32 v69, v8, v8, v37
    v_perm_b32 v70, v8, v8, v38
    v_perm_b32 v71, v8, v8, v39
    v_perm_b32 v72, v9, v9, v32
    v_perm_b32 v73, v9, v9, v33
    v_perm_b32 v74, v9, v9, v34
    v_perm_b32 v75, v9, v9, v35
    v_perm_b32 v76, v9, v9, v36
    v_perm_b32 v77, v9, v9, v37
    v_perm_b32 v78, v9, v9, v38
    v_perm_b32 v79, v9, v9, v39
    v_mfma_f32_16x16x32_bf16 v[96:99], v[64:67], a[0:3], v[96:99]
    v_mfma_f32_16x16x32_bf16 v[96:99], v[68:71], a[4:7], v[96:99]
    v_mfma_f32_16x16x32_bf16 v[96:99], v[72:75], a[8:11], v[96:99]
    v_mfma_f32_16x16x32_bf16 v[96:99], v[76:79], a[12:15], v[96:99]
    s_cmp_lg_u32 s3, 1
    s_cbranch_scc1 L_noffn14
    v_mfma_f32_16x16x32_bf16 v[108:111], v[64:67], a[48:51], v[108:111]
    v_mfma_f32_16x16x32_bf16 v[108:111], v[68:71], a[52:55], v[108:111]
    v_mfma_f32_16x16x32_bf16 v[108:111], v[72:75], a[56:59], v[108:111]
    v_mfma_f32_16x16x32_bf16 v[108:111], v[76:79], a[60:63], v[108:111]
L_noffn14:
    buffer_load_dwordx4 v[8:11], v30, s[12:15], s49 offen offset:0 sc1
    s_or_b32 s38, s38, s61
    s_branch L_poll16c
L_poll16:
    s_and_b32 s39, s38, s61
    s_cselect_b32 s61, s61, 1
    s_cselect_b32 s39, 0, 524288
    s_add_u32 s39, s39, s49
    s_mov_b64 exec, s[62:63]
    buffer_load_dwordx4 v[8:11], v30, s[12:15], s39 offen offset:0 sc1
    s_mov_b64 exec, -1
    s_sub_u32 s38, s38, 1
    s_cbranch_scc1 L_end
L_poll16c:
    s_waitcnt vmcnt(0)
L_poll16d:
    v_cmp_ne_u32 s[62:63], s36, v11
    s_cmp_lg_u64 s[62:63], 0
    s_cbranch_scc1 L_poll16
    v_perm_b32 v11, v9, v8, s59
    v_perm_b32 v11, v10, v11, s60
    v_mov_b32 v12, v8
    v_mov_b32 v13, v9
    v_mov_b32 v14, v10
    v_mov_b32 v15, v11
    v_permlane16_swap_b32 v8, v12
    v_permlane16_swap_b32 v9, v13
    v_permlane16_swap_b32 v10, v14
    v_permlane16_swap_b32 v11, v15
    v_add_f32 v8, v8, v12
    v_add_f32 v9, v9, v13
    v_add_f32 v10, v10, v14
    v_add_f32 v11, v11, v15
    v_mov_b32 v12, v8
    v_mov_b32 v13, v9
    v_mov_b32 v14, v10
    v_mov_b32 v15, v11
    v_permlane32_swap_b32 v8, v12
    v_permlane32_swap_b32 v9, v13
    v_permlane32_swap_b32 v10, v14
    v_permlane32_swap_b32 v11, v15
    v_add_f32 v8, v8, v12
    v_add_f32 v9, v9, v13
    v_add_f32 v10, v10, v14
    v_add_f32 v11, v11, v15
    v_mul_f32 v8, v8, v248
    v_mul_f32 v9, v9, v248
    v_mul_f32 v10, v10, v248
    v_mul_f32 v11, v11, v248
    v_cvt_pk_bf16_f32 v8, v8, v9
    v_cvt_pk_bf16_f32 v9, v10, v11
    s_mov_b64 exec, 0xffff
    ds_write_b64 v244, v[8:9] offset:64
    s_mov_b64 exec, -1
    s_waitcnt lgkmcnt(0)
    ds_read_b128 v[8:11], v245 offset:64
    s_waitcnt lgkmcnt(0)
    v_perm_b32 v64, v8, v8, v32
    v_perm_b32 v65, v8, v8, v33
    v_perm_b32 v66, v8, v8, v34
    v_perm_b32 v67, v8, v8, v35
    v_perm_b32 v68, v8, v8, v36
    v_perm_b32 v69, v8, v8, v37
    v_perm_b32 v70, v8, v8, v38
    v_perm_b32 v71, v8, v8, v39
    v_perm_b32 v72, v9, v9, v32
    v_perm_b32 v73, v9, v9, v33
    v_perm_b32 v74, v9, v9, v34
    v_perm_b32 v75, v9, v9, v35
    v_mfma_f32_16x16x32_bf16 v[96:99], v[64:67], a[16:19], v[96:99]
    v_perm_b32 v76, v9, v9, v36
    v_perm_b32 v77, v9, v9, v37
    v_perm_b32 v78, v9, v9, v38
    v_perm_b32 v79, v9, v9, v39
    v_mfma_f32_16x16x32_bf16 v[96:99], v[68:71], a[20:23], v[96:99]
    v_perm_b32 v80, v10, v10, v32
    v_perm_b32 v81, v10, v10, v33
    v_perm_b32 v82, v10, v10, v34
    v_perm_b32 v83, v10, v10, v35
    v_mfma_f32_16x16x32_bf16 v[96:99], v[72:75], a[24:27], v[96:99]
    v_perm_b32 v84, v10, v10, v36
    v_perm_b32 v85, v10, v10, v37
    v_perm_b32 v86, v10, v10, v38
    v_perm_b32 v87, v10, v10, v39
    v_mfma_f32_16x16x32_bf16 v[96:99], v[76:79], a[28:31], v[96:99]
    v_perm_b32 v88, v11, v11, v32
    v_perm_b32 v89, v11, v11, v33
    v_perm_b32 v90, v11, v11, v34
    v_perm_b32 v91, v11, v11, v35
    v_mfma_f32_16x16x32_bf16 v[96:99], v[80:83], a[32:35], v[96:99]
    v_perm_b32 v92, v11, v11, v36
    v_perm_b32 v93, v11, v11, v37
    v_perm_b32 v94, v11, v11, v38
    v_perm_b32 v95, v11, v11, v39
    v_mfma_f32_16x16x32_bf16 v[96:99], v[84:87], a[36:39], v[96:99]
    v_mfma_f32_16x16x32_bf16 v[96:99], v[88:91], a[40:43], v[96:99]
    v_mfma_f32_16x16x32_bf16 v[96:99], v[92:95], a[44:47], v[96:99]
    s_cmp_lg_u32 s3, 1
    s_cbranch_scc1 L_s5s17
    v_mfma_f32_16x16x32_bf16 v[108:111], v[64:67], a[64:67], v[108:111]
    v_mfma_f32_16x16x32_bf16 v[108:111], v[68:71], a[68:71], v[108:111]
    v_mfma_f32_16x16x32_bf16 v[108:111], v[72:75], a[72:75], v[108:111]
    v_mfma_f32_16x16x32_bf16 v[108:111], v[76:79], a[76:79], v[108:111]
    v_mfma_f32_16x16x32_bf16 v[108:111], v[80:83], a[80:83], v[108:111]
    v_mfma_f32_16x16x32_bf16 v[108:111], v[84:87], a[84:87], v[108:111]
    v_mfma_f32_16x16x32_bf16 v[108:111], v[88:91], a[88:91], v[108:111]
    v_mfma_f32_16x16x32_bf16 v[108:111], v[92:95], a[92:95], v[108:111]
    v_perm_b32 v100, v96, v99, s56
    v_perm_b32 v101, v97, v99, s57
    v_perm_b32 v102, v98, v99, s58
    buffer_store_dwordx4 v[100:103], v246, s[12:15], s50 offen sc1
    s_add_u32 s50, s50, 393216
    s_nop 2
    v_perm_b32 v112, v108, v111, s56
    v_perm_b32 v113, v109, v111, s57
    v_perm_b32 v114, v110, v111, s58
    buffer_store_dwordx4 v[112:115], v246, s[12:15], s50 offen sc1
    s_branch L_s5s17e
L_s5s17:
    s_nop 5
    v_perm_b32 v100, v96, v99, s56
    v_perm_b32 v101, v97, v99, s57
    v_perm_b32 v102, v98, v99, s58
    buffer_store_dwordx4 v[100:103], v246, s[12:15], s50 offen sc1
L_s5s17e:
    s_branch L_fin
L_A:
    s_lshr_b32 s40, s4, 2
    s_and_b32 s41, s4, 3
    s_lshl_b32 s41, s41, 3
    s_and_b32 s43, s5, 7
    s_add_u32 s41, s41, s43
    s_lshr_b32 s42, s5, 3
    s_load_dwordx2 s[24:25], s[0:1], 32
    s_load_dwordx2 s[28:29], s[0:1], 88
    s_mov_b32 s26, 4194304
    s_mov_b32 s27, 0x00020000
    s_mov_b32 s30, 2560
    s_lshl_b32 s51, s42, 13
    s_add_u32 s51, s51, 1245184
    s_lshl_b32 s52, s40, 16
    s_lshl_b32 s47, s42, 15
    s_add_u32 s52, s52, s47
    s_lshl_b32 s47, s3, 13
    s_add_u32 s52, s52, s47
    s_add_u32 s52, s52, 1114112
    s_add_u32 s53, s52, 4096
    v_mul_u32_u24 v8, 1040, v2
    v_lshl_add_u32 v8, v3, 4, v8
    s_mul_i32 s45, s3, 33280
    v_add_u32 v8, s45, v8
    s_mul_i32 s48, s42, 16640
    s_sub_u32 s49, 16640, s48
    v_add_u32 v31, s49, v8
    v_add_u32 v8, s48, v8
    v_lshrrev_b32 v9, 3, v1
    v_and_b32 v10, 3, v1
    v_bfe_u32 v11, v1, 2, 1
    v_lshlrev_b32 v21, 10, v9
    v_lshl_add_u32 v21, v10, 8, v21
    v_lshl_add_u32 v21, v11, 3, v21
    v_add_u32 v21, 133120, v21
    v_and_b32 v9, 3, v9
    v_lshl_add_u32 v9, v9, 2, v10
    s_lshl_b32 s46, s3, 2
    v_xor_b32 v9, s46, v9
    v_xor_b32 v10, 0, v9
    v_lshl_add_u32 v12, v10, 4, v21
    v_xor_b32 v10, 1, v9
    v_lshl_add_u32 v13, v10, 4, v21
    v_xor_b32 v10, 2, v9
    v_lshl_add_u32 v14, v10, 4, v21
    v_xor_b32 v10, 3, v9
    v_lshl_add_u32 v15, v10, 4, v21
    v_xor_b32 v9, v3, v2
    v_lshlrev_b32 v10, 8, v3
    v_add_u32 v10, 133120, v10
    v_xor_b32 v11, 0, v9
    v_lshl_add_u32 v16, v11, 4, v10
    v_xor_b32 v11, 4, v9
    v_lshl_add_u32 v17, v11, 4, v10
    v_xor_b32 v11, 8, v9
    v_lshl_add_u32 v18, v11, 4, v10
    v_xor_b32 v11, 12, v9
    v_lshl_add_u32 v19, v11, 4, v10
    v_lshrrev_b32 v9, 2, v2
    v_lshl_add_u32 v9, v3, 2, v9
    v_mul_u32_u24 v232, 1040, v9
    v_bfe_u32 v9, v2, 1, 1
    v_lshl_add_u32 v232, v9, 7, v232
    v_and_b32 v9, 1, v2
    v_lshl_add_u32 v232, v9, 3, v232
    s_lshl_b32 s46, s3, 8
    v_add_u32 v232, s46, v232
    v_add_u32 v233, s49, v232
    v_add_u32 v232, s48, v232
    v_add_u32 v234, 66560, v232
    v_add_u32 v235, 66560, v233
    v_lshlrev_b32 v22, 4, v2
    v_add_u32 v22, 149504, v22
    s_lshl_b32 s46, s3, 2
    v_add_u32 v23, s46, v22
    v_add_u32 v24, 150016, v30
    s_lshl_b32 s46, s3, 10
    v_add_u32 v25, s46, v24
    v_lshlrev_b32 v26, 18, v3
    v_lshl_add_u32 v26, v2, 4, v26
    s_lshl_b32 s54, s42, 6
    s_add_u32 s54, s54, s3
    s_lshl_b32 s54, s54, 14
    s_lshl_b32 s47, s41, 1
    s_add_u32 s47, s47, s40
    s_lshl_b32 s47, s47, 8
    s_add_u32 s54, s54, s47
    s_add_u32 s54, s54, 2097152
    s_lshl_b32 s55, s42, 6
    s_lshl_b32 s47, s40, 5
    s_add_u32 s55, s55, s47
    s_add_u32 s55, s55, s41
    s_lshl_b32 s55, s55, 8
    s_add_u32 s55, s55, 1277952
    v_mov_b32 v239, s36
    s_lshl_b32 s44, s6, 2
    s_add_u32 s44, s44, s7
    v_lshlrev_b32 v240, 13, v3
    v_lshl_add_u32 v240, v2, 4, v240
    s_lshl_b32 s45, s7, 2
    s_add_u32 s45, s45, s3
    s_lshl_b32 s45, s45, 18
    s_lshl_b32 s46, s6, 8
    s_add_u32 s45, s45, s46
    s_mul_i32 s46, s3, 8448
    v_lshrrev_b32 v9, 2, v2
    v_mul_u32_u24 v241, 2112, v9
    v_lshl_add_u32 v241, v3, 8, v241
    v_and_b32 v9, 3, v2
    v_lshl_add_u32 v241, v9, 3, v241
    s_lshl_b32 s39, s3, 6
    v_add_u32 v241, s39, v241
    v_lshlrev_b32 v242, 12, v3
    v_lshl_add_u32 v242, v2, 4, v242
    s_lshl_b32 s39, s3, 8
    v_add_u32 v242, s39, v242
    v_lshlrev_b32 v243, 8, v1
    v_lshlrev_b32 v244, 1, v1
    v_add_u32 v244, 133632, v244
    v_lshrrev_b32 v9, 3, v2
    v_lshlrev_b32 v245, 6, v9
    v_lshl_add_u32 v245, v3, 4, v245
    v_add_u32 v245, 133632, v245
    v_lshrrev_b32 v9, 1, v3
    v_lshlrev_b32 v246, 8, v9
    v_lshl_add_u32 v246, v2, 4, v246
    v_cmp_eq_u32 s[32:33], s3, v9
    v_and_b32 v9, 1, v3
    v_lshl_add_u32 v246, v9, 3, v246
    v_add_u32 v246, 133120, v246
    v_and_b32 v9, 1, v2
    v_lshlrev_b32 v247, 8, v9
    v_lshl_add_u32 v247, v3, 4, v247
    v_add_u32 v247, 133120, v247
    v_bfe_u32 v10, v2, 1, 1
    v_cmp_ne_u32 s[34:35], 0, v10
    v_lshlrev_b32 v248, 7, v10
    v_lshl_add_u32 v248, v9, 6, v248
    v_lshl_add_u32 v248, v3, 4, v248
    v_mov_b32 v208, -1
    v_mov_b32 v209, -1
    v_mov_b32 v210, -1
    v_mov_b32 v211, -1
    s_cmp_lg_u32 s3, 1
    s_cbranch_scc1 L_w18
    s_mov_b64 exec, 0xffff
    buffer_store_dwordx4 v[208:211], v30, s[12:15], s55 offen sc1
    s_mov_b64 exec, -1
L_w18:
    s_cmp_lt_u32 s3, 2
    s_cbranch_scc1 L_w19
    s_add_u32 s74, s74, 16384
    s_add_u32 s75, s75, 16640
    s_add_u32 s76, s75, 16640
L_dma20:
    s_mov_b32 m0, s75
    s_add_u32 s75, s75, 1040
    buffer_load_dwordx4 v30, s[16:19], s74 offen lds
    s_add_u32 s74, s74, 1024
    s_cmp_lt_u32 s75, s76
    s_cbranch_scc1 L_dma20
    s_lshl_b32 s47, s42, 5
    s_add_u32 s47, s47, 32
    s_lshl_b32 s76, s47, 10
    s_sub_u32 s74, s74, s76
    s_mul_i32 s76, s47, 1040
    s_sub_u32 s75, s75, s76
    s_add_u32 s76, s75, 16640
L_dma21:
    s_mov_b32 m0, s75
    s_add_u32 s75, s75, 1040
    buffer_load_dwordx4 v30, s[16:19], s74 offen lds
    s_add_u32 s74, s74, 1024
    s_cmp_lt_u32 s75, s76
    s_cbranch_scc1 L_dma21
    s_add_u32 s74, s74, 16384
    s_add_u32 s75, s75, 16640
    s_add_u32 s76, s75, 16640
L_dma22:
    s_mov_b32 m0, s75
    s_add_u32 s75, s75, 1040
    buffer_load_dwordx4 v30, s[16:19], s74 offen lds
    s_add_u32 s74, s74, 1024
    s_cmp_lt_u32 s75, s76
    s_cbranch_scc1 L_dma22
    s_waitcnt vmcnt(32)
L_w19:
    s_waitcnt lgkmcnt(0)
    s_barrier
    buffer_load_dwordx4 v[40:43], v30, s[12:15], s52 offen offset:0 sc1
    buffer_load_dwordx4 v[44:47], v30, s[12:15], s52 offen offset:1024 sc1
    buffer_load_dwordx4 v[48:51], v30, s[12:15], s52 offen offset:2048 sc1
    buffer_load_dwordx4 v[52:55], v30, s[12:15], s52 offen offset:3072 sc1
    buffer_load_dwordx4 v[56:59], v30, s[12:15], s53 offen offset:0 sc1
    buffer_load_dwordx4 v[60:63], v30, s[12:15], s53 offen offset:1024 sc1
    buffer_load_dwordx4 v[64:67], v30, s[12:15], s53 offen offset:2048 sc1
    buffer_load_dwordx4 v[68:71], v30, s[12:15], s53 offen offset:3072 sc1
    ds_read_b128 a[0:3], v8 offset:0
    ds_read_b128 a[4:7], v8 offset:64
    ds_read_b128 a[8:11], v8 offset:128
    ds_read_b128 a[12:15], v8 offset:192
    ds_read_b128 a[16:19], v8 offset:256
    ds_read_b128 a[20:23], v8 offset:320
    ds_read_b128 a[24:27], v8 offset:384
    ds_read_b128 a[28:31], v8 offset:448
    ds_read_b128 a[32:35], v8 offset:512
    ds_read_b128 a[36:39], v8 offset:576
    ds_read_b128 a[40:43], v8 offset:640
    ds_read_b128 a[44:47], v8 offset:704
    ds_read_b128 a[48:51], v8 offset:768
    ds_read_b128 a[52:55], v8 offset:832
    ds_read_b128 a[56:59], v8 offset:896
    ds_read_b128 a[60:63], v8 offset:960
    ds_read_b64_tr_b16 a[128:129], v232 offset:0
    ds_read_b64_tr_b16 a[132:133], v232 offset:33280
    ds_read_b64_tr_b16 a[136:137], v234 offset:0
    ds_read_b64_tr_b16 a[140:141], v234 offset:33280
    ds_read_b64_tr_b16 a[144:145], v232 offset:16
    ds_read_b64_tr_b16 a[148:149], v232 offset:33296
    ds_read_b64_tr_b16 a[152:153], v234 offset:16
    ds_read_b64_tr_b16 a[156:157], v234 offset:33296
    ds_read_b64_tr_b16 a[160:161], v232 offset:32
    ds_read_b64_tr_b16 a[164:165], v232 offset:33312
    ds_read_b64_tr_b16 a[168:169], v234 offset:32
    ds_read_b64_tr_b16 a[172:173], v234 offset:33312
    ds_read_b64_tr_b16 a[176:177], v232 offset:48
    ds_read_b64_tr_b16 a[180:181], v232 offset:33328
    ds_read_b64_tr_b16 a[184:185], v234 offset:48
    ds_read_b64_tr_b16 a[188:189], v234 offset:33328
    s_waitcnt vmcnt(8)
    s_barrier
    ds_read_b128 a[64:67], v31 offset:0
    ds_read_b128 a[68:71], v31 offset:64
    ds_read_b128 a[72:75], v31 offset:128
    ds_read_b128 a[76:79], v31 offset:192
    ds_read_b128 a[80:83], v31 offset:256
    ds_read_b128 a[84:87], v31 offset:320
    ds_read_b128 a[88:91], v31 offset:384
    ds_read_b128 a[92:95], v31 offset:448
    ds_read_b128 a[96:99], v31 offset:512
    ds_read_b128 a[100:103], v31 offset:576
    ds_read_b128 a[104:107], v31 offset:640
    ds_read_b128 a[108:111], v31 offset:704
    ds_read_b128 a[112:115], v31 offset:768
    ds_read_b128 a[116:119], v31 offset:832
    ds_read_b128 a[120:123], v31 offset:896
    ds_read_b128 a[124:127], v31 offset:960
    ds_read_b64_tr_b16 a[192:193], v232 offset:64
    ds_read_b64_tr_b16 a[196:197], v232 offset:33344
    ds_read_b64_tr_b16 a[200:201], v234 offset:64
    ds_read_b64_tr_b16 a[204:205], v234 offset:33344
    ds_read_b64_tr_b16 a[208:209], v232 offset:80
    ds_read_b64_tr_b16 a[212:213], v232 offset:33360
    ds_read_b64_tr_b16 a[216:217], v234 offset:80
    ds_read_b64_tr_b16 a[220:221], v234 offset:33360
    ds_read_b64_tr_b16 a[224:225], v232 offset:96
    ds_read_b64_tr_b16 a[228:229], v232 offset:33376
    ds_read_b64_tr_b16 a[232:233], v234 offset:96
    ds_read_b64_tr_b16 a[236:237], v234 offset:33376
    ds_read_b64_tr_b16 a[240:241], v232 offset:112
    ds_read_b64_tr_b16 a[244:245], v232 offset:33392
    ds_read_b64_tr_b16 a[248:249], v234 offset:112
    ds_read_b64_tr_b16 a[252:253], v234 offset:33392
    ds_read_b64_tr_b16 a[130:131], v233 offset:0
    ds_read_b64_tr_b16 a[134:135], v233 offset:33280
    ds_read_b64_tr_b16 a[138:139], v235 offset:0
    ds_read_b64_tr_b16 a[142:143], v235 offset:33280
    ds_read_b64_tr_b16 a[146:147], v233 offset:16
    ds_read_b64_tr_b16 a[150:151], v233 offset:33296
    ds_read_b64_tr_b16 a[154:155], v235 offset:16
    ds_read_b64_tr_b16 a[158:159], v235 offset:33296
    ds_read_b64_tr_b16 a[162:163], v233 offset:32
    ds_read_b64_tr_b16 a[166:167], v233 offset:33312
    ds_read_b64_tr_b16 a[170:171], v235 offset:32
    ds_read_b64_tr_b16 a[174:175], v235 offset:33312
    ds_read_b64_tr_b16 a[178:179], v233 offset:48
    ds_read_b64_tr_b16 a[182:183], v233 offset:33328
    ds_read_b64_tr_b16 a[186:187], v235 offset:48
    ds_read_b64_tr_b16 a[190:191], v235 offset:33328
    ds_read_b64_tr_b16 a[194:195], v233 offset:64
    ds_read_b64_tr_b16 a[198:199], v233 offset:33344
    ds_read_b64_tr_b16 a[202:203], v235 offset:64
    ds_read_b64_tr_b16 a[206:207], v235 offset:33344
    ds_read_b64_tr_b16 a[210:211], v233 offset:80
    ds_read_b64_tr_b16 a[214:215], v233 offset:33360
    ds_read_b64_tr_b16 a[218:219], v235 offset:80
    ds_read_b64_tr_b16 a[222:223], v235 offset:33360
    ds_read_b64_tr_b16 a[226:227], v233 offset:96
    ds_read_b64_tr_b16 a[230:231], v233 offset:33376
    ds_read_b64_tr_b16 a[234:235], v235 offset:96
    ds_read_b64_tr_b16 a[238:239], v235 offset:33376
    ds_read_b64_tr_b16 a[242:243], v233 offset:112
    ds_read_b64_tr_b16 a[246:247], v233 offset:33392
    ds_read_b64_tr_b16 a[250:251], v235 offset:112
    ds_read_b64_tr_b16 a[254:255], v235 offset:33392
    s_branch L_poll23c
L_poll23:
    s_mov_b64 exec, s[62:63]
    buffer_load_dwordx4 v[40:43], v30, s[12:15], s52 offen offset:0 sc1
    s_mov_b64 exec, s[64:65]
    buffer_load_dwordx4 v[44:47], v30, s[12:15], s52 offen offset:1024 sc1
    s_mov_b64 exec, s[66:67]
    buffer_load_dwordx4 v[48:51], v30, s[12:15], s52 offen offset:2048 sc1
    s_mov_b64 exec, s[68:69]
    buffer_load_dwordx4 v[52:55], v30, s[12:15], s52 offen offset:3072 sc1
    s_mov_b64 exec, s[70:71]
    buffer_load_dwordx4 v[56:59], v30, s[12:15], s53 offen offset:0 sc1
    s_mov_b64 exec, s[72:73]
    buffer_load_dwordx4 v[60:63], v30, s[12:15], s53 offen offset:1024 sc1
    s_mov_b64 exec, s[74:75]
    buffer_load_dwordx4 v[64:67], v30, s[12:15], s53 offen offset:2048 sc1
    s_mov_b64 exec, s[76:77]
    buffer_load_dwordx4 v[68:71], v30, s[12:15], s53 offen offset:3072 sc1
    s_mov_b64 exec, -1
    s_sub_u32 s38, s38, 1
    s_cbranch_scc1 L_end
L_poll23c:
    s_waitcnt vmcnt(0)
L_poll23d:
    v_cmp_ne_u32 s[62:63], s36, v43
    v_cmp_ne_u32 s[64:65], s36, v47
    v_cmp_ne_u32 s[66:67], s36, v51
    v_cmp_ne_u32 s[68:69], s36, v55
    v_cmp_ne_u32 s[70:71], s36, v59
    v_cmp_ne_u32 s[72:73], s36, v63
    v_cmp_ne_u32 s[74:75], s36, v67
    v_cmp_ne_u32 s[76:77], s36, v71
    s_or_b64 vcc, s[62:63], s[64:65]
    s_or_b64 vcc, vcc, s[66:67]
    s_or_b64 vcc, vcc, s[68:69]
    s_or_b64 vcc, vcc, s[70:71]
    s_or_b64 vcc, vcc, s[72:73]
    s_or_b64 vcc, vcc, s[74:75]
    s_or_b64 vcc, vcc, s[76:77]
    s_cbranch_scc1 L_poll23
    ds_write_b64 v12, v[40:41] offset:0
    ds_write_b64 v12, v[44:45] offset:8192
    ds_write_b64 v13, v[48:49] offset:0
    ds_write_b64 v13, v[52:53] offset:8192
    ds_write_b64 v14, v[56:57] offset:0
    ds_write_b64 v14, v[60:61] offset:8192
    ds_write_b64 v15, v[64:65] offset:0
    ds_write_b64 v15, v[68:69] offset:8192
    s_waitcnt lgkmcnt(0)
    s_barrier
    ds_read_b128 v[72:75], v16 offset:0
    ds_read_b128 v[76:79], v17 offset:1024
    ds_read_b128 v[80:83], v18 offset:2048
    ds_read_b128 v[84:87], v19 offset:3072
    ds_read_b128 v[88:91], v16 offset:4096
    ds_read_b128 v[92:95], v17 offset:5120
    ds_read_b128 v[96:99], v18 offset:6144
    ds_read_b128 v[100:103], v19 offset:7168
    ds_read_b128 v[104:107], v16 offset:8192
    s_waitcnt lgkmcnt(8)
    v_mfma_f32_16x16x32_bf16 v[136:139], a[0:3], v[72:75], 0
    v_mfma_f32_16x16x32_bf16 v[140:143], a[64:67], v[72:75], 0
    s_mov_b32 m0, s46
    s_add_u32 s46, s46, 1056
    buffer_load_dwordx4 v240, s[24:27], s45 offen nt lds
    s_add_u32 s45, s45, 32768
    ds_read_b128 v[108:111], v17 offset:9216
    s_waitcnt lgkmcnt(8)
    v_mfma_f32_16x16x32_bf16 v[136:139], a[4:7], v[76:79], v[136:139]
    v_mfma_f32_16x16x32_bf16 v[140:143], a[68:71], v[76:79], v[140:143]
    s_mov_b32 m0, s46
    s_add_u32 s46, s46, 1056
    buffer_load_dwordx4 v240, s[24:27], s45 offen nt lds
    s_add_u32 s45, s45, 32768
    ds_read_b128 v[112:115], v18 offset:10240
    s_waitcnt lgkmcnt(8)
    v_mfma_f32_16x16x32_bf16 v[136:139], a[8:11], v[80:83], v[136:139]
    v_mfma_f32_16x16x32_bf16 v[140:143], a[72:75], v[80:83], v[140:143]
    s_mov_b32 m0, s46
    s_add_u32 s46, s46, 1056
    buffer_load_dwordx4 v240, s[24:27], s45 offen nt lds
    s_add_u32 s45, s45, 32768
    ds_read_b128 v[116:119], v19 offset:11264
    s_waitcnt lgkmcnt(8)
    v_mfma_f32_16x16x32_bf16 v[136:139], a[12:15], v[84:87], v[136:139]
    v_mfma_f32_16x16x32_bf16 v[140:143], a[76:79], v[84:87], v[140:143]
    s_mov_b32 m0, s46
    s_add_u32 s46, s46, 1056
    buffer_load_dwordx4 v240, s[24:27], s45 offen nt lds
    s_add_u32 s45, s45, 32768
    ds_read_b128 v[120:123], v16 offset:12288
    s_waitcnt lgkmcnt(8)
    v_mfma_f32_16x16x32_bf16 v[136:139], a[16:19], v[88:91], v[136:139]
    v_mfma_f32_16x16x32_bf16 v[140:143], a[80:83], v[88:91], v[140:143]
    s_mov_b32 m0, s46
    s_add_u32 s46, s46, 1056
    buffer_load_dwordx4 v240, s[24:27], s45 offen nt lds
    s_add_u32 s45, s45, 32768
    ds_read_b128 v[124:127], v17 offset:13312
    s_waitcnt lgkmcnt(8)
    v_mfma_f32_16x16x32_bf16 v[136:139], a[20:23], v[92:95], v[136:139]
    v_mfma_f32_16x16x32_bf16 v[140:143], a[84:87], v[92:95], v[140:143]
    s_mov_b32 m0, s46
    s_add_u32 s46, s46, 1056
    buffer_load_dwordx4 v240, s[24:27], s45 offen nt lds
    s_add_u32 s45, s45, 32768
    ds_read_b128 v[128:131], v18 offset:14336
    s_waitcnt lgkmcnt(8)
    v_mfma_f32_16x16x32_bf16 v[136:139], a[24:27], v[96:99], v[136:139]
    v_mfma_f32_16x16x32_bf16 v[140:143], a[88:91], v[96:99], v[140:143]
    s_mov_b32 m0, s46
    s_add_u32 s46, s46, 1056
    buffer_load_dwordx4 v240, s[24:27], s45 offen nt lds
    s_add_u32 s45, s45, 32768
    ds_read_b128 v[132:135], v19 offset:15360
    s_waitcnt lgkmcnt(8)
    v_mfma_f32_16x16x32_bf16 v[136:139], a[28:31], v[100:103], v[136:139]
    v_mfma_f32_16x16x32_bf16 v[140:143], a[92:95], v[100:103], v[140:143]
    s_mov_b32 m0, s46
    s_add_u32 s46, s46, 1056
    buffer_load_dwordx4 v240, s[24:27], s45 offen nt lds
    s_add_u32 s45, s45, 32768
    s_waitcnt lgkmcnt(7)
    v_mfma_f32_16x16x32_bf16 v[136:139], a[32:35], v[104:107], v[136:139]
    v_mfma_f32_16x16x32_bf16 v[140:143], a[96:99], v[104:107], v[140:143]
    s_waitcnt lgkmcnt(6)
    v_mfma_f32_16x16x32_bf16 v[136:139], a[36:39], v[108:111], v[136:139]
    v_mfma_f32_16x16x32_bf16 v[140:143], a[100:103], v[108:111], v[140:143]
    s_waitcnt lgkmcnt(5)
    v_mfma_f32_16x16x32_bf16 v[136:139], a[40:43], v[112:115], v[136:139]
    v_mfma_f32_16x16x32_bf16 v[140:143], a[104:107], v[112:115], v[140:143]
    s_waitcnt lgkmcnt(4)
    v_mfma_f32_16x16x32_bf16 v[136:139], a[44:47], v[116:119], v[136:139]
    v_mfma_f32_16x16x32_bf16 v[140:143], a[108:111], v[116:119], v[140:143]
    s_waitcnt lgkmcnt(3)
    v_mfma_f32_16x16x32_bf16 v[136:139], a[48:51], v[120:123], v[136:139]
    v_mfma_f32_16x16x32_bf16 v[140:143], a[112:115], v[120:123], v[140:143]
    s_waitcnt lgkmcnt(2)
    v_mfma_f32_16x16x32_bf16 v[136:139], a[52:55], v[124:127], v[136:139]
    v_mfma_f32_16x16x32_bf16 v[140:143], a[116:119], v[124:127], v[140:143]
    s_waitcnt lgkmcnt(1)
    v_mfma_f32_16x16x32_bf16 v[136:139], a[56:59], v[128:131], v[136:139]
    v_mfma_f32_16x16x32_bf16 v[140:143], a[120:123], v[128:131], v[140:143]
    s_waitcnt lgkmcnt(0)
    v_mfma_f32_16x16x32_bf16 v[136:139], a[60:63], v[132:135], v[136:139]
    v_mfma_f32_16x16x32_bf16 v[140:143], a[124:127], v[132:135], v[140:143]
    s_nop 6
    v_max3_f32 v4, v136, v137, v138
    v_max3_f32 v5, v139, v140, v141
    v_max3_f32 v4, v4, v142, v143
    v_max_f32 v4, v4, v5
    v_mov_b32 v5, v4
    s_nop 1
    v_permlane16_swap_b32 v4, v5
    v_max_f32 v4, v4, v5
    v_mov_b32 v5, v4
    s_nop 1
    v_permlane32_swap_b32 v4, v5
    v_max_f32 v4, v4, v5
    ds_write_b32 v23, v4
    s_waitcnt lgkmcnt(0)
    s_barrier
    ds_read_b128 v[4:7], v22
    s_waitcnt lgkmcnt(0)
    v_max3_f32 v4, v4, v5, v6
    v_max_f32 v237, v4, v7
    v_sub_f32 v136, v136, v237
    v_sub_f32 v137, v137, v237
    v_sub_f32 v138, v138, v237
    v_sub_f32 v139, v139, v237
    v_sub_f32 v140, v140, v237
    v_sub_f32 v141, v141, v237
    v_sub_f32 v142, v142, v237
    v_sub_f32 v143, v143, v237
    v_exp_f32 v136, v136
    v_exp_f32 v137, v137
    v_exp_f32 v138, v138
    v_exp_f32 v139, v139
    v_exp_f32 v140, v140
    v_exp_f32 v141, v141
    v_exp_f32 v142, v142
    v_exp_f32 v143, v143
    v_cvt_pk_bf16_f32 v4, v136, v137
    v_cvt_pk_bf16_f32 v5, v138, v139
    v_cvt_pk_bf16_f32 v6, v140, v141
    v_cvt_pk_bf16_f32 v7, v142, v143
    ds_write_b128 v25, v[4:7]
    v_add_f32 v9, v136, v137
    v_add_f32 v10, v138, v139
    v_add_f32 v11, v140, v141
    v_add_f32 v12, v142, v143
    v_add_f32 v9, v9, v10
    v_add_f32 v11, v11, v12
    v_add_f32 v9, v9, v11
    v_mov_b32 v10, v9
    s_nop 1
    v_permlane16_swap_b32 v9, v10
    v_add_f32 v9, v9, v10
    v_mov_b32 v10, v9
    s_nop 1
    v_permlane32_swap_b32 v9, v10
    v_add_f32 v9, v9, v10
    ds_write_b32 v23, v9 offset:256
    s_waitcnt lgkmcnt(0)
    s_barrier
    ds_read_b128 v[144:147], v24 offset:0
    ds_read_b128 v[148:151], v24 offset:1024
    ds_read_b128 v[152:155], v24 offset:2048
    ds_read_b128 v[156:159], v24 offset:3072
    ds_read_b128 v[4:7], v22 offset:256
    s_and_b32 s53, s37, 1
    s_mul_i32 s53, s53, 0x10001
    s_mov_b32 s52, 0x10001
    v_mov_b32 v212, s53
    s_waitcnt lgkmcnt(4)
    v_mfma_f32_16x16x32_bf16 v[160:163], v[144:147], a[128:131], 0
    s_waitcnt lgkmcnt(3)
    v_mfma_f32_16x16x32_bf16 v[160:163], v[148:151], a[132:135], v[160:163]
    s_waitcnt lgkmcnt(2)
    v_mfma_f32_16x16x32_bf16 v[160:163], v[152:155], a[136:139], v[160:163]
    s_waitcnt lgkmcnt(1)
    v_mfma_f32_16x16x32_bf16 v[160:163], v[156:159], a[140:143], v[160:163]
    s_cmp_lg_u32 s3, 3
    s_cbranch_scc1 L_w24
    s_waitcnt lgkmcnt(0)
    v_add_f32 v4, v4, v5
    v_add_f32 v6, v6, v7
    v_add_f32 v238, v4, v6
    s_mov_b64 exec, 0xffff
    buffer_store_dwordx4 v[236:239], v30, s[12:15], s55 offen sc1
    s_mov_b64 exec, -1
    s_nop 3
L_w24:
    v_mfma_f32_16x16x32_bf16 v[164:167], v[144:147], a[144:147], 0
    v_mfma_f32_16x16x32_bf16 v[164:167], v[148:151], a[148:151], v[164:167]
    v_mfma_f32_16x16x32_bf16 v[164:167], v[152:155], a[152:155], v[164:167]
    v_mfma_f32_16x16x32_bf16 v[164:167], v[156:159], a[156:159], v[164:167]
    v_mfma_f32_16x16x32_bf16 v[168:171], v[144:147], a[160:163], 0
    v_mfma_f32_16x16x32_bf16 v[168:171], v[148:151], a[164:167], v[168:171]
    v_mfma_f32_16x16x32_bf16 v[168:171], v[152:155], a[168:171], v[168:171]
    v_mfma_f32_16x16x32_bf16 v[168:171], v[156:159], a[172:175], v[168:171]
    v_mfma_f32_16x16x32_bf16 v[172:175], v[144:147], a[176:179], 0
    v_mfma_f32_16x16x32_bf16 v[172:175], v[148:151], a[180:183], v[172:175]
    v_mfma_f32_16x16x32_bf16 v[172:175], v[152:155], a[184:187], v[172:175]
    v_mfma_f32_16x16x32_bf16 v[172:175], v[156:159], a[188:191], v[172:175]
    v_cvt_pk_bf16_f32 v192, v160, v164
    v_cvt_pk_bf16_f32 v196, v161, v165
    v_cvt_pk_bf16_f32 v200, v162, v166
    v_cvt_pk_bf16_f32 v204, v163, v167
    v_bfi_b32 v192, s52, v212, v192
    v_bfi_b32 v196, s52, v212, v196
    v_bfi_b32 v200, s52, v212, v200
    v_bfi_b32 v204, s52, v212, v204
    v_mfma_f32_16x16x32_bf16 v[176:179], v[144:147], a[192:195], 0
    v_mfma_f32_16x16x32_bf16 v[176:179], v[148:151], a[196:199], v[176:179]
    v_mfma_f32_16x16x32_bf16 v[176:179], v[152:155], a[200:203], v[176:179]
    v_mfma_f32_16x16x32_bf16 v[176:179], v[156:159], a[204:207], v[176:179]
    v_mfma_f32_16x16x32_bf16 v[180:183], v[144:147], a[208:211], 0
    v_mfma_f32_16x16x32_bf16 v[180:183], v[148:151], a[212:215], v[180:183]
    v_mfma_f32_16x16x32_bf16 v[180:183], v[152:155], a[216:219], v[180:183]
    v_mfma_f32_16x16x32_bf16 v[180:183], v[156:159], a[220:223], v[180:183]
    v_cvt_pk_bf16_f32 v193, v168, v172
    v_cvt_pk_bf16_f32 v197, v169, v173
    v_cvt_pk_bf16_f32 v201, v170, v174
    v_cvt_pk_bf16_f32 v205, v171, v175
    v_bfi_b32 v193, s52, v212, v193
    v_bfi_b32 v197, s52, v212, v197
    v_bfi_b32 v201, s52, v212, v201
    v_bfi_b32 v205, s52, v212, v205
    v_mfma_f32_16x16x32_bf16 v[184:187], v[144:147], a[224:227], 0
    v_mfma_f32_16x16x32_bf16 v[184:187], v[148:151], a[228:231], v[184:187]
    v_mfma_f32_16x16x32_bf16 v[184:187], v[152:155], a[232:235], v[184:187]
    v_mfma_f32_16x16x32_bf16 v[184:187], v[156:159], a[236:239], v[184:187]
    v_mfma_f32_16x16x32_bf16 v[188:191], v[144:147], a[240:243], 0
    v_mfma_f32_16x16x32_bf16 v[188:191], v[148:151], a[244:247], v[188:191]
    v_mfma_f32_16x16x32_bf16 v[188:191], v[152:155], a[248:251], v[188:191]
    v_mfma_f32_16x16x32_bf16 v[188:191], v[156:159], a[252:255], v[188:191]
    v_cvt_pk_bf16_f32 v194, v176, v180
    v_cvt_pk_bf16_f32 v198, v177, v181
    v_cvt_pk_bf16_f32 v202, v178, v182
    v_cvt_pk_bf16_f32 v206, v179, v183
    v_bfi_b32 v194, s52, v212, v194
    v_bfi_b32 v198, s52, v212, v198
    v_bfi_b32 v202, s52, v212, v202
    v_bfi_b32 v206, s52, v212, v206
    s_lshr_b32 s43, s6, 4
    s_lshl_b32 s43, s43, 14
    s_and_b32 s47, s6, 15
    s_lshl_b32 s47, s47, 4
    s_add_u32 s43, s43, s47
    s_add_u32 s43, s43, 1277952
    v_cvt_pk_bf16_f32 v195, v184, v188
    v_bfi_b32 v195, s52, v212, v195
    buffer_store_dwordx4 v[192:195], v26, s[12:15], s54 offen sc1
    s_add_u32 s54, s54, 65536
    v_cvt_pk_bf16_f32 v199, v185, v189
    v_bfi_b32 v199, s52, v212, v199
    buffer_store_dwordx4 v[196:199], v26, s[12:15], s54 offen sc1
    s_add_u32 s54, s54, 65536
    v_cvt_pk_bf16_f32 v203, v186, v190
    v_bfi_b32 v203, s52, v212, v203
    buffer_store_dwordx4 v[200:203], v26, s[12:15], s54 offen sc1
    s_add_u32 s54, s54, 65536
    v_cvt_pk_bf16_f32 v207, v187, v191
    v_bfi_b32 v207, s52, v212, v207
    buffer_store_dwordx4 v[204:207], v26, s[12:15], s54 offen sc1
    s_lshl_b32 s42, s44, 14
    s_add_u32 s42, s42, 2097152
    s_lshl_b32 s51, s6, 2
    s_add_u32 s51, s51, s3
    s_lshl_b32 s51, s51, 2
    s_add_u32 s51, s51, s7
    s_lshl_b32 s51, s51, 8
    s_add_u32 s51, s51, 458752
    v_mov_b32 v51, s36
    s_cmp_lg_u32 s3, 3
    s_cbranch_scc1 L_A_h3w
    buffer_load_dwordx4 v[12:15], v243, s[12:15], s43 offen offset:0 sc1
    s_branch L_poll25c
L_poll25:
    s_mov_b64 exec, s[62:63]
    buffer_load_dwordx4 v[12:15], v243, s[12:15], s43 offen offset:0 sc1
    s_mov_b64 exec, -1
    s_sub_u32 s38, s38, 1
    s_cbranch_scc1 L_end
L_poll25c:
    s_waitcnt vmcnt(0)
L_poll25d:
    v_cmp_ne_u32 s[62:63], s36, v15
    s_cmp_lg_u64 s[62:63], 0
    s_cbranch_scc1 L_poll25
    s_barrier
    v_mov_b32 v16, v13
    s_nop 1
    v_max_f32_dpp v16, v16, v16 row_ror:1 row_mask:0xf bank_mask:0xf
    s_nop 1
    v_max_f32_dpp v16, v16, v16 row_ror:2 row_mask:0xf bank_mask:0xf
    s_nop 1
    v_max_f32_dpp v16, v16, v16 row_ror:4 row_mask:0xf bank_mask:0xf
    s_nop 1
    v_max_f32_dpp v16, v16, v16 row_ror:8 row_mask:0xf bank_mask:0xf
    v_mov_b32 v17, v16
    s_nop 1
    v_permlane16_swap_b32 v16, v17
    v_max_f32 v16, v16, v17
    v_sub_f32 v16, v13, v16
    v_exp_f32 v16, v16
    s_nop 0
    v_mul_f32 v18, v16, v14
    s_nop 1
    v_add_f32_dpp v18, v18, v18 row_ror:1 row_mask:0xf bank_mask:0xf
    s_nop 1
    v_add_f32_dpp v18, v18, v18 row_ror:2 row_mask:0xf bank_mask:0xf
    s_nop 1
    v_add_f32_dpp v18, v18, v18 row_ror:4 row_mask:0xf bank_mask:0xf
    s_nop 1
    v_add_f32_dpp v18, v18, v18 row_ror:8 row_mask:0xf bank_mask:0xf
    v_mov_b32 v17, v18
    s_nop 1
    v_permlane16_swap_b32 v18, v17
    v_add_f32 v18, v18, v17
    v_rcp_f32 v18, v18
    s_nop 0
    v_mul_f32 v16, v16, v18
    v_cvt_pk_bf16_f32 v16, v16, v16
    ds_write_b16 v244, v16
    s_waitcnt lgkmcnt(0)
    s_barrier
    ds_read_b64_tr_b16 v[208:209], v241 offset:0
    ds_read_b64_tr_b16 v[210:211], v241 offset:8448
    ds_read_b64_tr_b16 v[212:213], v241 offset:1056
    ds_read_b64_tr_b16 v[214:215], v241 offset:9504
    ds_read_b64_tr_b16 v[216:217], v241 offset:16896
    ds_read_b64_tr_b16 v[218:219], v241 offset:25344
    ds_read_b64_tr_b16 v[220:221], v241 offset:17952
    ds_read_b64_tr_b16 v[222:223], v241 offset:26400
    ds_read_b64_tr_b16 v[224:225], v241 offset:32
    ds_read_b64_tr_b16 v[226:227], v241 offset:8480
    ds_read_b64_tr_b16 v[228:229], v241 offset:1088
    ds_read_b64_tr_b16 v[230:231], v241 offset:9536
    ds_read_b64_tr_b16 v[232:233], v241 offset:16928
    ds_read_b64_tr_b16 v[234:235], v241 offset:25376
    ds_read_b64_tr_b16 v[236:237], v241 offset:17984
    ds_read_b64_tr_b16 v[238:239], v241 offset:26432
    s_branch L_A_b2
L_A_h3w:
    s_waitcnt vmcnt(4)
    s_barrier
    s_cmp_lg_u32 s3, 2
    s_cbranch_scc1 L_A_h3w2
    ds_read_b64_tr_b16 v[208:209], v241 offset:0
    ds_read_b64_tr_b16 v[210:211], v241 offset:8448
    ds_read_b64_tr_b16 v[212:213], v241 offset:1056
    ds_read_b64_tr_b16 v[214:215], v241 offset:9504
    ds_read_b64_tr_b16 v[216:217], v241 offset:16896
    ds_read_b64_tr_b16 v[218:219], v241 offset:25344
    ds_read_b64_tr_b16 v[220:221], v241 offset:17952
    ds_read_b64_tr_b16 v[222:223], v241 offset:26400
    ds_read_b64_tr_b16 v[224:225], v241 offset:32
    ds_read_b64_tr_b16 v[226:227], v241 offset:8480
    ds_read_b64_tr_b16 v[228:229], v241 offset:1088
    ds_read_b64_tr_b16 v[230:231], v241 offset:9536
    ds_read_b64_tr_b16 v[232:233], v241 offset:16928
    ds_read_b64_tr_b16 v[234:235], v241 offset:25376
    ds_read_b64_tr_b16 v[236:237], v241 offset:17984
    ds_read_b64_tr_b16 v[238:239], v241 offset:26432
    s_barrier
    s_branch L_A_b2
L_A_h3w2:
    buffer_load_dwordx4 v[144:147], v242, s[12:15], s42 offen offset:0 sc1
    buffer_load_dwordx4 v[148:151], v242, s[12:15], s42 offen offset:512 sc1
    buffer_load_dwordx4 v[152:155], v242, s[12:15], s42 offen offset:1024 sc1
    buffer_load_dwordx4 v[156:159], v242, s[12:15], s42 offen offset:1536 sc1
    buffer_load_dwordx4 v[160:163], v242, s[12:15], s42 offen offset:2048 sc1
    buffer_load_dwordx4 v[164:167], v242, s[12:15], s42 offen offset:2560 sc1
    buffer_load_dwordx4 v[168:171], v242, s[12:15], s42 offen offset:3072 sc1
    buffer_load_dwordx4 v[172:175], v242, s[12:15], s42 offen offset:3584 sc1
    ds_read_b64_tr_b16 v[208:209], v241 offset:0
    ds_read_b64_tr_b16 v[210:211], v241 offset:8448
    ds_read_b64_tr_b16 v[212:213], v241 offset:1056
    ds_read_b64_tr_b16 v[214:215], v241 offset:9504
    ds_read_b64_tr_b16 v[216:217], v241 offset:16896
    ds_read_b64_tr_b16 v[218:219], v241 offset:25344
    ds_read_b64_tr_b16 v[220:221], v241 offset:17952
    ds_read_b64_tr_b16 v[222:223], v241 offset:26400
    ds_read_b64_tr_b16 v[224:225], v241 offset:32
    ds_read_b64_tr_b16 v[226:227], v241 offset:8480
    ds_read_b64_tr_b16 v[228:229], v241 offset:1088
    ds_read_b64_tr_b16 v[230:231], v241 offset:9536
    ds_read_b64_tr_b16 v[232:233], v241 offset:16928
    ds_read_b64_tr_b16 v[234:235], v241 offset:25376
    ds_read_b64_tr_b16 v[236:237], v241 offset:17984
    ds_read_b64_tr_b16 v[238:239], v241 offset:26432
    s_barrier
    ds_read_b128 v[16:19], v245
    s_waitcnt lgkmcnt(0)
    v_perm_b32 v176, v16, v16, v32
    v_perm_b32 v177, v16, v16, v33
    v_perm_b32 v178, v16, v16, v34
    v_perm_b32 v179, v16, v16, v35
    v_perm_b32 v180, v16, v16, v36
    v_perm_b32 v181, v16, v16, v37
    v_perm_b32 v182, v16, v16, v38
    v_perm_b32 v183, v16, v16, v39
    v_perm_b32 v184, v17, v17, v32
    v_perm_b32 v185, v17, v17, v33
    v_perm_b32 v186, v17, v17, v34
    v_perm_b32 v187, v17, v17, v35
    v_perm_b32 v188, v17, v17, v36
    v_perm_b32 v189, v17, v17, v37
    v_perm_b32 v190, v17, v17, v38
    v_perm_b32 v191, v17, v17, v39
    v_perm_b32 v192, v18, v18, v32
    v_perm_b32 v193, v18, v18, v33
    v_perm_b32 v194, v18, v18, v34
    v_perm_b32 v195, v18, v18, v35
    v_perm_b32 v196, v18, v18, v36
    v_perm_b32 v197, v18, v18, v37
    v_perm_b32 v198, v18, v18, v38
    v_perm_b32 v199, v18, v18, v39
    v_perm_b32 v200, v19, v19, v32
    v_perm_b32 v201, v19, v19, v33
    v_perm_b32 v202, v19, v19, v34
    v_perm_b32 v203, v19, v19, v35
    v_perm_b32 v204, v19, v19, v36
    v_perm_b32 v205, v19, v19, v37
    v_perm_b32 v206, v19, v19, v38
    v_perm_b32 v207, v19, v19, v39
    s_mov_b32 s47, 0xfffefffe
    s_branch L_A_plc
L_A_plr:
    s_nop 7
    buffer_load_dwordx4 v[144:147], v242, s[12:15], s42 offen offset:0 sc1
    buffer_load_dwordx4 v[148:151], v242, s[12:15], s42 offen offset:512 sc1
    buffer_load_dwordx4 v[152:155], v242, s[12:15], s42 offen offset:1024 sc1
    buffer_load_dwordx4 v[156:159], v242, s[12:15], s42 offen offset:1536 sc1
    buffer_load_dwordx4 v[160:163], v242, s[12:15], s42 offen offset:2048 sc1
    buffer_load_dwordx4 v[164:167], v242, s[12:15], s42 offen offset:2560 sc1
    buffer_load_dwordx4 v[168:171], v242, s[12:15], s42 offen offset:3072 sc1
    buffer_load_dwordx4 v[172:175], v242, s[12:15], s42 offen offset:3584 sc1
    s_sub_u32 s38, s38, 1
    s_cbranch_scc1 L_end
L_A_plc:
    v_mov_b32 v22, 0
    s_waitcnt vmcnt(7)
    v_bitop3_b32 v22, v22, v144, s53 bitop3:0xf6
    v_bitop3_b32 v22, v22, v145, s53 bitop3:0xf6
    v_bitop3_b32 v22, v22, v146, s53 bitop3:0xf6
    v_bitop3_b32 v22, v22, v147, s53 bitop3:0xf6
    v_and_b32 v144, s47, v144
    v_and_b32 v145, s47, v145
    v_and_b32 v146, s47, v146
    v_and_b32 v147, s47, v147
    s_nop 1
    v_mfma_f32_16x16x32_bf16 v[16:19], v[176:179], v[144:147], 0
    s_waitcnt vmcnt(6)
    v_bitop3_b32 v22, v22, v148, s53 bitop3:0xf6
    v_bitop3_b32 v22, v22, v149, s53 bitop3:0xf6
    v_bitop3_b32 v22, v22, v150, s53 bitop3:0xf6
    v_bitop3_b32 v22, v22, v151, s53 bitop3:0xf6
    v_or_b32 v148, s52, v148
    v_or_b32 v149, s52, v149
    v_or_b32 v150, s52, v150
    v_or_b32 v151, s52, v151
    s_nop 1
    v_mfma_f32_16x16x32_bf16 v[16:19], v[180:183], v[148:151], v[16:19]
    s_waitcnt vmcnt(5)
    v_bitop3_b32 v22, v22, v152, s53 bitop3:0xf6
    v_bitop3_b32 v22, v22, v153, s53 bitop3:0xf6
    v_bitop3_b32 v22, v22, v154, s53 bitop3:0xf6
    v_bitop3_b32 v22, v22, v155, s53 bitop3:0xf6
    v_and_b32 v152, s47, v152
    v_and_b32 v153, s47, v153
    v_and_b32 v154, s47, v154
    v_and_b32 v155, s47, v155
    s_nop 1
    v_mfma_f32_16x16x32_bf16 v[16:19], v[184:187], v[152:155], v[16:19]
    s_waitcnt vmcnt(4)
    v_bitop3_b32 v22, v22, v156, s53 bitop3:0xf6
    v_bitop3_b32 v22, v22, v157, s53 bitop3:0xf6
    v_bitop3_b32 v22, v22, v158, s53 bitop3:0xf6
    v_bitop3_b32 v22, v22, v159, s53 bitop3:0xf6
    v_or_b32 v156, s52, v156
    v_or_b32 v157, s52, v157
    v_or_b32 v158, s52, v158
    v_or_b32 v159, s52, v159
    s_nop 1
    v_mfma_f32_16x16x32_bf16 v[16:19], v[188:191], v[156:159], v[16:19]
    s_waitcnt vmcnt(3)
    v_bitop3_b32 v22, v22, v160, s53 bitop3:0xf6
    v_bitop3_b32 v22, v22, v161, s53 bitop3:0xf6
    v_bitop3_b32 v22, v22, v162, s53 bitop3:0xf6
    v_bitop3_b32 v22, v22, v163, s53 bitop3:0xf6
    v_and_b32 v160, s47, v160
    v_and_b32 v161, s47, v161
    v_and_b32 v162, s47, v162
    v_and_b32 v163, s47, v163
    s_nop 1
    v_mfma_f32_16x16x32_bf16 v[16:19], v[192:195], v[160:163], v[16:19]
    s_waitcnt vmcnt(2)
    v_bitop3_b32 v22, v22, v164, s53 bitop3:0xf6
    v_bitop3_b32 v22, v22, v165, s53 bitop3:0xf6
    v_bitop3_b32 v22, v22, v166, s53 bitop3:0xf6
    v_bitop3_b32 v22, v22, v167, s53 bitop3:0xf6
    v_or_b32 v164, s52, v164
    v_or_b32 v165, s52, v165
    v_or_b32 v166, s52, v166
    v_or_b32 v167, s52, v167
    s_nop 1
    v_mfma_f32_16x16x32_bf16 v[16:19], v[196:199], v[164:167], v[16:19]
    s_waitcnt vmcnt(1)
    v_bitop3_b32 v22, v22, v168, s53 bitop3:0xf6
    v_bitop3_b32 v22, v22, v169, s53 bitop3:0xf6
    v_bitop3_b32 v22, v22, v170, s53 bitop3:0xf6
    v_bitop3_b32 v22, v22, v171, s53 bitop3:0xf6
    v_and_b32 v168, s47, v168
    v_and_b32 v169, s47, v169
    v_and_b32 v170, s47, v170
    v_and_b32 v171, s47, v171
    s_nop 1
    v_mfma_f32_16x16x32_bf16 v[16:19], v[200:203], v[168:171], v[16:19]
    s_waitcnt vmcnt(0)
    v_bitop3_b32 v22, v22, v172, s53 bitop3:0xf6
    v_bitop3_b32 v22, v22, v173, s53 bitop3:0xf6
    v_bitop3_b32 v22, v22, v174, s53 bitop3:0xf6
    v_bitop3_b32 v22, v22, v175, s53 bitop3:0xf6
    v_or_b32 v172, s52, v172
    v_or_b32 v173, s52, v173
    v_or_b32 v174, s52, v174
    v_or_b32 v175, s52, v175
    s_nop 1
    v_mfma_f32_16x16x32_bf16 v[16:19], v[204:207], v[172:175], v[16:19]
    v_and_b32 v22, s52, v22
    v_cmp_ne_u32 vcc, 0, v22
    s_cbranch_vccnz L_A_plr
    s_nop 4
    v_cvt_pk_bf16_f32 v20, v16, v17
    v_cvt_pk_bf16_f32 v21, v18, v19
    s_mov_b64 exec, s[32:33]
    ds_write_b64 v246, v[20:21]
    s_mov_b64 exec, -1
L_A_b2:
    s_waitcnt lgkmcnt(0)
    s_barrier
    ds_read_b128 v[8:11], v247 offset:0
    ds_read_b128 v[12:15], v247 offset:64
    ds_read_b128 v[16:19], v247 offset:128
    ds_read_b128 v[20:23], v247 offset:192
    s_waitcnt lgkmcnt(3)
    v_mfma_f32_16x16x32_bf16 v[56:59], v[208:211], v[8:11], 0
    v_mfma_f32_16x16x32_bf16 v[60:63], v[224:227], v[8:11], 0
    s_waitcnt lgkmcnt(2)
    v_mfma_f32_16x16x32_bf16 v[56:59], v[212:215], v[12:15], v[56:59]
    v_mfma_f32_16x16x32_bf16 v[60:63], v[228:231], v[12:15], v[60:63]
    s_waitcnt lgkmcnt(1)
    v_mfma_f32_16x16x32_bf16 v[56:59], v[216:219], v[16:19], v[56:59]
    v_mfma_f32_16x16x32_bf16 v[60:63], v[232:235], v[16:19], v[60:63]
    s_waitcnt lgkmcnt(0)
    v_mfma_f32_16x16x32_bf16 v[56:59], v[220:223], v[20:23], v[56:59]
    v_mfma_f32_16x16x32_bf16 v[60:63], v[236:239], v[20:23], v[60:63]
    s_nop 7
    v_cndmask_b32 v56, v56, v60, s[34:35]
    v_cndmask_b32 v57, v57, v61, s[34:35]
    v_cndmask_b32 v58, v58, v62, s[34:35]
    v_cndmask_b32 v59, v59, v63, s[34:35]
    v_perm_b32 v48, v56, v59, s56
    v_perm_b32 v49, v57, v59, s57
    v_perm_b32 v50, v58, v59, s58
    s_mov_b32 exec_lo, 0x000f000f
    s_mov_b32 exec_hi, 0x000f000f
    buffer_store_dwordx4 v[48:51], v248, s[12:15], s51 offen
    s_add_u32 s39, s51, 524288
    buffer_store_dwordx4 v[48:51], v248, s[12:15], s39 offen sc1
    s_mov_b64 exec, -1
    s_cmp_ge_u32 s2, 168
    s_cbranch_scc1 L_fin
    s_sub_u32 s41, s2, 128
    v_lshlrev_b32 v30, 4, v0
    s_lshl_b32 s46, s41, 14
    s_add_u32 s46, s46, 1310720
    s_add_u32 s47, s46, 4096
    s_add_u32 s48, s46, 8192
    s_add_u32 s49, s46, 12288
    v_and_b32 v24, 7, v1
    s_lshl_b32 s50, s3, 7
    s_add_u32 s50, s50, 155200
    v_lshl_add_u32 v25, v24, 4, s50
    v_lshlrev_b32 v27, 4, v24
    v_add_u32 v26, 155200, v27
    s_lshr_b32 s51, s41, 3
    s_bfe_u32 s54, s41, 0x20001
    s_and_b32 s55, s41, 1
    s_lshr_b32 s40, s54, 1
    s_mul_i32 s40, s40, 1280
    s_lshl_b32 s51, s51, 8
    s_add_u32 s40, s40, s51
    s_lshl_b32 s55, s55, 7
    s_add_u32 s40, s40, s55
    s_and_b32 s54, s54, 1
    s_lshl_b32 s54, s54, 3
    s_add_u32 s40, s40, s54
    buffer_load_dwordx4 v[8:11], v30, s[12:15], s46 offen offset:0 sc1
    buffer_load_dwordx4 v[12:15], v30, s[12:15], s47 offen offset:0 sc1
    buffer_load_dwordx4 v[16:19], v30, s[12:15], s48 offen offset:0 sc1
    buffer_load_dwordx4 v[20:23], v30, s[12:15], s49 offen offset:0 sc1
    s_branch L_poll26c
L_poll26:
    s_mov_b64 exec, s[62:63]
    buffer_load_dwordx4 v[8:11], v30, s[12:15], s46 offen offset:0 sc1
    s_mov_b64 exec, s[64:65]
    buffer_load_dwordx4 v[12:15], v30, s[12:15], s47 offen offset:0 sc1
    s_mov_b64 exec, s[66:67]
    buffer_load_dwordx4 v[16:19], v30, s[12:15], s48 offen offset:0 sc1
    s_mov_b64 exec, s[68:69]
    buffer_load_dwordx4 v[20:23], v30, s[12:15], s49 offen offset:0 sc1
    s_mov_b64 exec, -1
    s_sub_u32 s38, s38, 1
    s_cbranch_scc1 L_end
L_poll26c:
    s_waitcnt vmcnt(0)
L_poll26d:
    v_cmp_ne_u32 s[62:63], s36, v11
    v_cmp_ne_u32 s[64:65], s36, v15
    v_cmp_ne_u32 s[66:67], s36, v19
    v_cmp_ne_u32 s[68:69], s36, v23
    s_or_b64 vcc, s[62:63], s[64:65]
    s_or_b64 vcc, vcc, s[66:67]
    s_or_b64 vcc, vcc, s[68:69]
    s_cbranch_scc1 L_poll26
    v_perm_b32 v11, v9, v8, s59
    v_perm_b32 v11, v10, v11, s60
    v_perm_b32 v15, v13, v12, s59
    v_perm_b32 v15, v14, v15, s60
    v_perm_b32 v19, v17, v16, s59
    v_perm_b32 v19, v18, v19, s60
    v_perm_b32 v23, v21, v20, s59
    v_perm_b32 v23, v22, v23, s60
    v_pk_add_f32 v[8:9], v[8:9], v[12:13]
    v_pk_add_f32 v[10:11], v[10:11], v[14:15]
    v_pk_add_f32 v[16:17], v[16:17], v[20:21]
    v_pk_add_f32 v[18:19], v[18:19], v[22:23]
    v_pk_add_f32 v[8:9], v[8:9], v[16:17]
    v_pk_add_f32 v[10:11], v[10:11], v[18:19]
    s_nop 0
    v_add_f32_dpp v8, v8, v8 row_ror:8 row_mask:0xf bank_mask:0xf
    v_add_f32_dpp v9, v9, v9 row_ror:8 row_mask:0xf bank_mask:0xf
    v_add_f32_dpp v10, v10, v10 row_ror:8 row_mask:0xf bank_mask:0xf
    v_add_f32_dpp v11, v11, v11 row_ror:8 row_mask:0xf bank_mask:0xf
    v_mov_b32 v12, v8
    v_mov_b32 v13, v9
    v_mov_b32 v14, v10
    v_mov_b32 v15, v11
    v_permlane16_swap_b32 v8, v12
    v_permlane16_swap_b32 v9, v13
    v_permlane16_swap_b32 v10, v14
    v_permlane16_swap_b32 v11, v15
    v_add_f32 v8, v8, v12
    v_add_f32 v9, v9, v13
    v_add_f32 v10, v10, v14
    v_add_f32 v11, v11, v15
    v_mov_b32 v12, v8
    v_mov_b32 v13, v9
    v_mov_b32 v14, v10
    v_mov_b32 v15, v11
    v_permlane32_swap_b32 v8, v12
    v_permlane32_swap_b32 v9, v13
    v_permlane32_swap_b32 v10, v14
    v_permlane32_swap_b32 v11, v15
    v_add_f32 v8, v8, v12
    v_add_f32 v9, v9, v13
    v_add_f32 v10, v10, v14
    v_add_f32 v11, v11, v15
    s_mov_b64 exec, 0xff
    ds_write_b128 v25, v[8:11]
    s_waitcnt lgkmcnt(0)
    s_barrier
    s_cmp_lg_u32 s3, 0
    s_cbranch_scc1 L_fin
    ds_read_b128 v[12:15], v26 offset:128
    ds_read_b128 v[16:19], v26 offset:256
    ds_read_b128 v[20:23], v26 offset:384
    s_waitcnt lgkmcnt(0)
    v_pk_add_f32 v[8:9], v[8:9], v[12:13]
    v_pk_add_f32 v[10:11], v[10:11], v[14:15]
    v_pk_add_f32 v[16:17], v[16:17], v[20:21]
    v_pk_add_f32 v[18:19], v[18:19], v[22:23]
    v_pk_add_f32 v[8:9], v[8:9], v[16:17]
    v_pk_add_f32 v[10:11], v[10:11], v[18:19]
    v_cvt_pk_bf16_f32 v8, v8, v9
    v_cvt_pk_bf16_f32 v9, v10, v11
    buffer_store_dwordx2 v[8:9], v27, s[28:31], s40 offen
    s_cmp_lg_u32 s41, 0
    s_cbranch_scc1 L_fin
    s_mov_b64 exec, 1
    v_mov_b32 v10, s37
    v_mov_b32 v11, 0
    buffer_store_dword v10, v11, s[12:15], 0 offen offset:0 sc1
L_fin:
L_end:
    s_endpgm
L_code_end:
.fill (16384 - (L_code_end - gated_mix__compressed_kv_cla__swiglu_ffn__decode_kernel)) / 4, 4, 0xBF810000
.section .rodata,"a"
.p2align 6
.amdhsa_kernel gated_mix__compressed_kv_cla__swiglu_ffn__decode_kernel
  .amdhsa_next_free_vgpr 512
  .amdhsa_next_free_sgpr 102
  .amdhsa_accum_offset 256
  .amdhsa_group_segment_fixed_size 0
  .amdhsa_kernarg_size 112
  .amdhsa_user_sgpr_count 2
  .amdhsa_user_sgpr_kernarg_segment_ptr 1
  .amdhsa_system_sgpr_workgroup_id_x 1
.end_amdhsa_kernel
```
